```python
import torch

def _softmax(x, axis=-1):
    return torch.softmax(x, dim=axis)
def _gelu(x):
    return torch.nn.functional.gelu(x, approximate="tanh")
def _silu(x):
    return torch.nn.functional.silu(x)
def _sigmoid(x):
    return torch.sigmoid(x)
def _layernorm(x, axis=-1, eps=1e-5):
    m = x.mean(dim=axis, keepdim=True)
    v = x.var(dim=axis, keepdim=True, unbiased=False)
    return (x - m) / torch.sqrt(v + eps)
def _scatter_add(tgt, idx, src, axis=0):
    return tgt.clone().index_add_(axis, idx, src)
def _segment_sum(src, seg, n):
    out = torch.zeros((n,) + src.shape[1:], dtype=src.dtype)
    return out.index_add_(0, seg, src)
def _pad(x, pw):
    flat = tuple(v for pair in reversed(pw) for v in pair)
    return torch.nn.functional.pad(x, flat)

kernel_name = 'parallel_sum__ssm_conv_s5__dense_activation_silu__prompt'

def setup_inputs():

    _w = (lambda a: (lambda t: t.to(torch.bfloat16) if t.is_floating_point() else t)(torch.as_tensor(a)))
    def _A_setup():
        B, S, D = 1, 2048, 512
        P = D
        Lambda_re = -0.5 * (lambda _x: torch.exp(torch.as_tensor(_x)))((lambda *s: torch.randn(*s, dtype=torch.bfloat16) * 0.2)(P))
        Lambda_im = (lambda *s: torch.randn(*s, dtype=torch.bfloat16) * 0.8)(P) * 1.0
        B_re = (lambda *s: torch.randn(*s, dtype=torch.bfloat16) * 0.2)(P, D) * (D ** -0.5)
        B_im = (lambda *s: torch.randn(*s, dtype=torch.bfloat16) * 0.2)(P, D) * (D ** -0.5)
        C_re = (lambda *s: torch.randn(*s, dtype=torch.bfloat16) * 0.2)(D, P) * (P ** -0.5)
        C_im = (lambda *s: torch.randn(*s, dtype=torch.bfloat16) * 0.2)(D, P) * (P ** -0.5)
        log_dt = (lambda *s: torch.randn(*s, dtype=torch.bfloat16) * 0.2)(P) * 0.3 - 2.0
        Dskip = (lambda *s: torch.randn(*s, dtype=torch.bfloat16) * 0.05)(D)
        return {
            "x": _w((lambda *s: torch.randn(*s, dtype=torch.bfloat16) * 0.05)(B, S, D)),
            "Lambda_re": _w(Lambda_re),
            "Lambda_im": _w(Lambda_im),
            "B_re": _w(B_re),
            "B_im": _w(B_im),
            "C_re": _w(C_re),
            "C_im": _w(C_im),
            "log_dt": _w(log_dt),
            "Dskip": _w(Dskip),
        }
    _A_in = _A_setup()

    def _B_setup():
        B, S, D, F = 1, 2048, 512, 1376
        return {
            "x": _w((lambda *s: torch.randn(*s, dtype=torch.bfloat16) * 0.05)(B, S, D)),
            "w1": _w((lambda *s: torch.randn(*s, dtype=torch.bfloat16) * 0.8)(D, F) * (D ** -0.5)),
            "w2": _w((lambda *s: torch.randn(*s, dtype=torch.bfloat16) * 0.2)(F, D) * (F ** -0.5)),
        }
    _B_in = _B_setup()

    return {
        "A_x": _A_in["x"],
        "A_Lambda_re": _A_in["Lambda_re"],
        "A_Lambda_im": _A_in["Lambda_im"],
        "A_B_re": _A_in["B_re"],
        "A_B_im": _A_in["B_im"],
        "A_C_re": _A_in["C_re"],
        "A_C_im": _A_in["C_im"],
        "A_log_dt": _A_in["log_dt"],
        "A_Dskip": _A_in["Dskip"],
        "B_x": _B_in["x"],
        "B_w1": _B_in["w1"],
        "B_w2": _B_in["w2"],
    }

def reference(A_x, A_Lambda_re, A_Lambda_im, A_B_re, A_B_im, A_C_re, A_C_im, A_log_dt, A_Dskip, B_x, B_w1, B_w2):
    def _A_ref(x, Lambda_re, Lambda_im, B_re, B_im, C_re, C_im, log_dt, Dskip):
        Bsz, L, H = x.shape
        Lam = Lambda_re + 1j * Lambda_im
        Bmat = B_re + 1j * B_im
        Cmat = C_re + 1j * C_im
        dt = torch.exp(log_dt)
        Lam_bar = torch.exp(dt * Lam)
        B_bar = ((Lam_bar - 1.0) / Lam)[:, None] * Bmat
        Bu = torch.einsum("bld,pd->blp", x + 0j, B_bar)
        h = torch.zeros_like(Bu[:, 0, :])
        hs = []
        for t in range(L):
            h = Lam_bar[None, :] * h + Bu[:, t, :]
            hs.append(h)
        hseq = torch.stack(hs, 1)
        y = 2.0 * torch.einsum("blp,dp->bld", hseq, Cmat).real + x * Dskip[None, None, :]
        return y

    def _B_ref(x, w1, w2):
        h = torch.einsum("bsd,df->bsf", x, w1)
        h = _silu(h)
        out = torch.einsum("bsf,fd->bsd", h, w2)
        return out

    x = A_x
    xn = _layernorm(x, axis=-1)
    return x + _A_ref(xn, A_Lambda_re, A_Lambda_im, A_B_re, A_B_im, A_C_re, A_C_im, A_log_dt, A_Dskip) + _B_ref(xn, B_w1, B_w2)
```

```asm
; @launch grid=(256,1,1) block=(512,1,1) lds=163840
.amdgcn_target "amdgcn-amd-amdhsa--gfx950"
.text
.globl parallel_sum__ssm_conv_s5__dense_activation_silu__prompt_kernel
.p2align 8
.type parallel_sum__ssm_conv_s5__dense_activation_silu__prompt_kernel,@function
parallel_sum__ssm_conv_s5__dense_activation_silu__prompt_kernel:
    s_cmp_ge_u32 s2, 0x100
    s_cbranch_scc1 L_end
    s_load_dwordx16 s[8:23], s[0:1], 0
    s_load_dwordx8 s[24:31], s[0:1], 64
    s_load_dwordx2 s[32:33], s[0:1], 96
    s_load_dwordx2 s[36:37], s[0:1], 112
    s_getpc_b64 s[4:5]
L_pcref:
    s_lshr_b32 s3, s2, 3
    s_and_b32 s3, s3, 15
    s_lshl_b32 s3, s3, 11
    v_lshl_add_u32 v3, v0, 2, s3
    v_and_b32 v3, 0xffffff80, v3
    v_min_u32 v3, L_end-L_pcref-256, v3
    v_and_b32 v4, 31, v0
    v_cmp_eq_u32 vcc, 0, v4
    s_nop 0
    s_mov_b64 exec, vcc
    global_load_dword v254, v3, s[4:5] offset:256
    s_mov_b64 exec, -1
    v_lshrrev_b32 v2, 6, v0
    v_and_b32 v1, 63, v0
    v_readfirstlane_b32 s72, v2
    s_and_b32 s80, s2, 7
    s_lshr_b32 s81, s2, 3
    s_and_b32 s83, s80, 1
    s_lshl_b32 s74, s83, 3
    s_and_b32 s77, s81, 7
    s_add_u32 s74, s74, s77
    s_lshr_b32 s3, s80, 1
    s_lshl_b32 s75, s3, 2
    s_lshr_b32 s82, s81, 3
    s_add_u32 s75, s75, s82
    s_lshl_b32 s76, s75, 1
    s_add_u32 s76, s76, s83
    s_and_b32 s73, s72, 3
    v_lshrrev_b32 v20, 5, v1
    s_mov_b32 s101, s75
    s_mul_i32 s98, s101, 3
    s_lshl_b32 s4, s101, 1
    s_add_u32 s4, s4, 11
    s_min_u32 s98, s98, s4
    v_lshlrev_b32 v31, 4, v1
    s_cmp_lt_u32 s72, 4
    s_cbranch_scc1 L_F
    s_mul_i32 s99, s77, 4
    s_mul_i32 s4, s83, 2
    s_add_u32 s99, s99, s4
    s_mul_i32 s4, s3, 2
    s_add_u32 s99, s99, s4
    v_and_b32 v24, 7, v1
    v_lshrrev_b32 v25, 4, v1
    v_xor_b32 v27, v24, v25
    v_lshlrev_b32 v27, 4, v27
    v_bfe_u32 v23, v1, 3, 2
    v_lshl_add_u32 v23, v20, 4, v23
    v_lshl_add_u32 v10, v23, 10, v27
    v_add_u32 v12, 0x1800, v10
    v_xor_b32 v11, 64, v10
    v_add_u32 v11, 0xc00, v11
    v_add_u32 v13, 0x1800, v11
    v_lshrrev_b32 v23, 2, v1
    v_mul_u32_u24 v23, 2752, v23
    v_and_b32 v24, 3, v1
    v_lshl_add_u32 v14, v24, 4, v23
    s_cmp_ge_u32 s101, 11
    s_cselect_b32 s80, 0x7ff00000, 0
    v_add_u32 v15, s80, v14
    s_lshl_b32 s6, s74, 17
    s_lshl_b32 s80, s73, 15
    s_add_u32 s6, s6, s80
    s_lshl_b32 s7, s73, 12
    s_mul_i32 s5, s73, 44032
    s_lshl_b32 s80, s98, 6
    s_add_u32 s5, s5, s80
    s_mul_i32 s82, s73, 3072
    s_mov_b32 s42, 0x200000
    s_mov_b32 s43, 0x20000
    s_mov_b32 s50, 1409024
    s_mov_b32 s51, 0x20000
    s_waitcnt lgkmcnt(0)
    s_mov_b32 s40, s8
    s_mov_b32 s41, s9
    s_mov_b32 s48, s28
    s_mov_b32 s49, s29
    s_load_dword s78, s[36:37], 0
    s_add_u32 s39, s99, 0
    s_and_b32 s39, s39, 7
    s_mul_i32 s39, s39, 176128
    s_add_u32 s39, s39, s5
    s_add_u32 m0, s82, 49152
    s_nop 0
    buffer_load_dwordx4 v14, s[48:51], s39 offen offset:0 lds
    s_add_u32 m0, s82, 50112
    s_nop 0
    buffer_load_dwordx4 v14, s[48:51], s39 offen offset:64 lds
    s_add_u32 m0, s82, 51072
    s_nop 0
    buffer_load_dwordx4 v15, s[48:51], s39 offen offset:128 lds
    s_add_u32 s39, s99, 0
    s_and_b32 s39, s39, 7
    s_mul_i32 s39, s39, 128
    s_add_u32 s39, s39, s6
    s_add_u32 m0, s7, 0
    s_nop 0
    buffer_load_dwordx4 v10, s[40:43], s39 offen offset:0 lds
    buffer_load_dwordx4 v11, s[40:43], s39 offen offset:1024 lds
    buffer_load_dwordx4 v12, s[40:43], s39 offen offset:2048 lds
    buffer_load_dwordx4 v13, s[40:43], s39 offen offset:3072 lds
    s_cmp_ge_u32 s73, 2
    s_cselect_b32 s44, s16, s14
    s_cselect_b32 s45, s17, s15
    s_mov_b32 s46, 0x80000
    s_mov_b32 s47, 0x20000
    s_mov_b32 s52, s30
    s_mov_b32 s53, s31
    s_mov_b32 s54, 0x158000
    s_mov_b32 s55, 0x20000
    s_mov_b32 s56, s18
    s_mov_b32 s57, s19
    s_mov_b32 s58, 0x80000
    s_mov_b32 s59, 0x20000
    s_mov_b32 s60, s20
    s_mov_b32 s61, s21
    s_mov_b32 s62, 0x80000
    s_mov_b32 s63, 0x20000
    s_mov_b32 s68, s36
    s_mov_b32 s69, s37
    s_mov_b32 s70, 0xe80000
    s_mov_b32 s71, 0x20000
    s_mov_b32 s38, 0xffff0000
    v_and_b32 v21, 31, v1
    v_bfe_u32 v22, v1, 1, 3
    v_xor_b32 v23, v20, v22
    v_lshlrev_b32 v23, 4, v23
    v_lshl_add_u32 v23, v21, 7, v23
    s_lshl_b32 s80, s73, 12
    v_add_u32 v2, s80, v23
    v_xor_b32 v3, 32, v2
    v_xor_b32 v4, 64, v2
    v_xor_b32 v5, 0x60, v2
    v_bfe_u32 v24, v1, 2, 1
    v_bfe_u32 v25, v1, 3, 2
    v_and_b32 v26, 3, v1
    v_lshl_add_u32 v26, v24, 4, v26
    v_lshl_add_u32 v26, v25, 2, v26
    v_lshrrev_b32 v24, 3, v26
    v_and_b32 v30, 7, v26
    v_lshlrev_b32 v30, 3, v30
    v_lshl_add_u32 v30, v24, 7, v30
    s_lshl_b32 s4, s74, 11
    s_lshl_b32 s80, s73, 9
    s_add_u32 s4, s4, s80
    s_add_u32 s4, s4, 32768
    v_mov_b32 v65, 0
    v_mov_b32 v66, 0
    v_mov_b32 v67, 0
    v_mov_b32 v69, 0
    v_mov_b32 v70, 0
    v_mov_b32 v71, 0
    v_mov_b32 v77, 0
    v_mov_b32 v78, 0
    v_mov_b32 v79, 0
    v_mov_b32 v73, 160768
    v_mov_b32 v74, 1
    v_lshrrev_b32 v23, 3, v1
    v_lshl_add_u32 v16, v23, 10, v27
    v_xor_b32 v17, 64, v16
    s_lshl_b32 s80, s73, 12
    s_sub_u32 s80, 86016, s80
    v_add_u32 v6, s80, v2
    v_add_u32 v7, s80, v3
    v_add_u32 v8, s80, v4
    v_add_u32 v9, s80, v5
    v_lshrrev_b32 v58, 1, v21
    v_lshlrev_b32 v58, 7, v58
    v_lshl_add_u32 v58, v20, 4, v58
    v_and_b32 v23, 1, v1
    v_lshl_add_u32 v58, v23, 3, v58
    s_lshl_b32 s17, s75, 11
    s_add_u32 s17, s17, 196608
    s_lshl_b32 s15, s75, 15
    s_and_b32 s80, s73, 1
    s_lshl_b32 s80, s80, 14
    s_add_u32 s15, s15, s80
    s_lshl_b32 s34, s73, 11
    s_lshl_b32 s35, s73, 14
    s_add_u32 s35, s35, 86016
    s_lshl_b32 s0, s77, 16
    s_lshl_b32 s80, s73, 8
    s_add_u32 s0, s0, s80
    s_add_u32 s1, s0, 128
    s_lshl_b32 s80, s73, 2
    s_sub_u32 s80, s74, s80
    s_sub_u32 s80, s80, 1
    v_sub_u32 v72, s80, v20
    v_lshlrev_b32 v23, 4, v21
    v_lshl_add_u32 v23, v72, 13, v23
    v_mov_b32 v24, 0x7ff00000
    v_subrev_u32 v18, 0, v23
    v_cmp_le_i32 vcc, 0, v72
    s_nop 1
    v_cndmask_b32 v18, v24, v18, vcc
    v_subrev_u32 v19, 16384, v23
    v_cmp_le_i32 vcc, 2, v72
    s_nop 1
    v_cndmask_b32 v19, v24, v19, vcc
    v_lshlrev_b32 v56, 3, v21
    v_add_u32 v56, 81920, v56
    s_lshl_b32 s80, s73, 9
    v_lshl_add_u32 v57, v1, 3, s80
    v_add_u32 v57, 81920, v57
    s_lshl_b32 s80, s73, 1
    v_add_u32 v59, s80, v20
    v_lshlrev_b32 v60, 6, v21
    v_lshl_add_u32 v60, v20, 5, v60
    v_add_u32 v60, s35, v60
    v_bfe_u32 v23, v1, 2, 2
    v_lshl_add_u32 v61, v20, 3, v23
    v_lshlrev_b32 v61, 6, v61
    v_and_b32 v23, 1, v1
    v_lshl_add_u32 v61, v23, 5, v61
    v_bfe_u32 v23, v1, 4, 1
    v_lshl_add_u32 v61, v23, 4, v61
    v_bfe_u32 v23, v1, 1, 1
    v_lshl_add_u32 v61, v23, 3, v61
    v_add_u32 v61, s35, v61
    s_lshl_b32 s80, s73, 7
    s_add_u32 s80, s80, 159744
    v_lshl_add_u32 v63, v20, 6, s80
    s_add_u32 s80, s80, 512
    v_lshl_add_u32 v62, v21, 2, s80
    v_mov_b32 v124, 0
    v_mov_b32 v125, 0
    s_lshl_b32 s81, s75, 9
    s_add_u32 s28, s81, 65536
    s_lshl_b32 s80, s74, 13
    s_add_u32 s29, s80, s28
    s_lshl_b32 s80, s74, 2
    s_add_u32 s80, s80, s73
    s_mul_i32 s80, s80, 155648
    s_lshl_b32 s81, s75, 12
    s_add_u32 s80, s80, s81
    s_add_u32 s30, s80, 5332992
    s_lshl_b32 s80, s73, 2
    s_lshr_b32 s81, s76, 1
    s_lshl_b32 s81, s81, 4
    s_add_u32 s80, s80, s81
    s_lshl_b32 s80, s80, 7
    s_add_u32 s80, s80, 819200
    s_and_b32 s81, s76, 1
    s_lshl_b32 s81, s81, 3
    s_add_u32 s80, s80, s81
    s_add_u32 s20, s36, s80
    s_addc_u32 s21, s37, 0
    s_lshl_b32 s80, s74, 4
    s_add_u32 s80, s80, s75
    s_lshl_b32 s80, s80, 7
    s_lshl_b32 s81, s73, 2
    s_add_u32 s80, s80, s81
    s_add_u32 s80, s80, 819200
    s_add_u32 s26, s36, s80
    s_addc_u32 s27, s37, 0
    s_add_u32 s39, s99, 1
    s_and_b32 s39, s39, 7
    s_mul_i32 s39, s39, 176128
    s_add_u32 s39, s39, s5
    s_add_u32 m0, s82, 61440
    s_nop 0
    buffer_load_dwordx4 v14, s[48:51], s39 offen offset:0 lds
    s_add_u32 m0, s82, 62400
    s_nop 0
    buffer_load_dwordx4 v14, s[48:51], s39 offen offset:64 lds
    s_add_u32 m0, s82, 63360
    s_nop 0
    buffer_load_dwordx4 v15, s[48:51], s39 offen offset:128 lds
    s_add_u32 s39, s99, 1
    s_and_b32 s39, s39, 7
    s_mul_i32 s39, s39, 128
    s_add_u32 s39, s39, s6
    s_add_u32 m0, s7, 16384
    s_nop 0
    buffer_load_dwordx4 v10, s[40:43], s39 offen offset:0 lds
    buffer_load_dwordx4 v11, s[40:43], s39 offen offset:1024 lds
    buffer_load_dwordx4 v12, s[40:43], s39 offen offset:2048 lds
    buffer_load_dwordx4 v13, s[40:43], s39 offen offset:3072 lds
    s_waitcnt vmcnt(7)
    s_waitcnt lgkmcnt(0)
    s_add_u32 s78, s78, 0x9e3779b9
    s_mov_b32 s79, s78
    s_barrier
    ds_read_b128 v[250:253], v2 offset:0
    ds_read_b128 v[246:249], v3 offset:0
    ds_read_b128 v[242:245], v4 offset:0
    ds_read_b128 v[238:241], v5 offset:0
    s_add_u32 s39, s99, 2
    s_and_b32 s39, s39, 7
    s_mul_i32 s39, s39, 176128
    s_add_u32 s39, s39, s5
    s_add_u32 m0, s82, 73728
    s_nop 0
    buffer_load_dwordx4 v14, s[48:51], s39 offen offset:0 lds
    s_add_u32 m0, s82, 74688
    s_nop 0
    buffer_load_dwordx4 v14, s[48:51], s39 offen offset:64 lds
    s_add_u32 m0, s82, 75648
    s_nop 0
    buffer_load_dwordx4 v15, s[48:51], s39 offen offset:128 lds
    s_add_u32 s39, s99, 2
    s_and_b32 s39, s39, 7
    s_mul_i32 s39, s39, 128
    s_add_u32 s39, s39, s6
    s_add_u32 m0, s7, 32768
    s_nop 0
    buffer_load_dwordx4 v10, s[40:43], s39 offen offset:0 lds
    buffer_load_dwordx4 v11, s[40:43], s39 offen offset:1024 lds
    buffer_load_dwordx4 v12, s[40:43], s39 offen offset:2048 lds
    buffer_load_dwordx4 v13, s[40:43], s39 offen offset:3072 lds
    s_lshl_b32 s31, s2, 2
    s_add_u32 s31, s31, s73
    v_lshlrev_b32 v75, 7, v1
    s_mul_i32 s33, s31, 1408
    s_mov_b64 exec, 0x7ff
    buffer_load_dword v254, v75, s[52:55], s33 offen
    s_lshl_b32 s33, s31, 9
    s_mov_b64 exec, 0xf
    buffer_load_dword v254, v75, s[56:59], s33 offen
    buffer_load_dword v254, v75, s[60:63], s33 offen
    s_mov_b64 exec, -1
    s_waitcnt vmcnt(10) lgkmcnt(0)
    s_barrier
    ds_read_b128 v[234:237], v2 offset:16384
    ds_read_b128 v[230:233], v3 offset:16384
    ds_read_b128 v[226:229], v4 offset:16384
    ds_read_b128 v[222:225], v5 offset:16384
    v_lshlrev_b32 v75, 1, v21
    v_add_u32 v75, 162880, v75
    ds_read_u16 v134, v75 offset:0
    ds_read_u16 v135, v75 offset:128
    ds_read_u16 v136, v75 offset:256
    s_add_u32 s39, s99, 3
    s_and_b32 s39, s39, 7
    s_mul_i32 s39, s39, 176128
    s_add_u32 s39, s39, s5
    s_add_u32 m0, s82, 49152
    s_nop 0
    buffer_load_dwordx4 v14, s[48:51], s39 offen offset:0 lds
    s_add_u32 m0, s82, 50112
    s_nop 0
    buffer_load_dwordx4 v14, s[48:51], s39 offen offset:64 lds
    s_add_u32 m0, s82, 51072
    s_nop 0
    buffer_load_dwordx4 v15, s[48:51], s39 offen offset:128 lds
    s_add_u32 s39, s99, 3
    s_and_b32 s39, s39, 7
    s_mul_i32 s39, s39, 128
    s_add_u32 s39, s39, s6
    s_add_u32 m0, s7, 0
    s_nop 0
    buffer_load_dwordx4 v10, s[40:43], s39 offen offset:0 lds
    buffer_load_dwordx4 v11, s[40:43], s39 offen offset:1024 lds
    buffer_load_dwordx4 v12, s[40:43], s39 offen offset:2048 lds
    buffer_load_dwordx4 v13, s[40:43], s39 offen offset:3072 lds
    s_waitcnt lgkmcnt(0)
    v_lshlrev_b32 v134, 16, v134
    v_lshlrev_b32 v135, 16, v135
    v_lshlrev_b32 v136, 16, v136
    v_mul_f32 v136, 0x3fb8aa3b, v136
    v_exp_f32 v136, v136
    s_nop 0
    v_cvt_pk_bf16_f32 v136, v136, v136
    v_lshlrev_b32 v136, 16, v136
    v_mul_f32 v126, v136, v134
    v_mul_f32 v127, v136, v135
    v_mul_f32 v126, 0x3fb8aa3b, v126
    v_exp_f32 v126, v126
    v_mul_f32 v127, 0.15915494, v127
    v_rndne_f32 v128, v127
    v_sub_f32 v127, v127, v128
    v_cos_f32 v128, v127
    v_sin_f32 v129, v127
    v_mul_f32 v112, v126, v128
    v_mul_f32 v113, v126, v129
    v_add_f32 v126, -1.0, v112
    v_mul_f32 v127, v134, v134
    v_fmac_f32 v127, v135, v135
    v_rcp_f32 v127, v127
    v_mul_f32 v128, v126, v134
    v_fmac_f32 v128, v113, v135
    v_mul_f32 v129, v113, v134
    v_fma_f32 v129, -v126, v135, v129
    v_add_f32 v127, v127, v127
    v_mul_f32 v114, v128, v127
    v_mul_f32 v115, v129, v127
    v_mul_f32 v126, v112, v112
    s_waitcnt vmcnt(10)
    s_barrier
    ds_read_b128 v[218:221], v2 offset:32768
    ds_read_b128 v[214:217], v3 offset:32768
    ds_read_b128 v[210:213], v4 offset:32768
    ds_read_b128 v[206:209], v5 offset:32768
    s_add_u32 s39, s99, 4
    s_and_b32 s39, s39, 7
    s_mul_i32 s39, s39, 176128
    s_add_u32 s39, s39, s5
    s_add_u32 m0, s82, 61440
    s_nop 0
    buffer_load_dwordx4 v14, s[48:51], s39 offen offset:0 lds
    s_add_u32 m0, s82, 62400
    s_nop 0
    buffer_load_dwordx4 v14, s[48:51], s39 offen offset:64 lds
    s_add_u32 m0, s82, 63360
    s_nop 0
    buffer_load_dwordx4 v15, s[48:51], s39 offen offset:128 lds
    s_add_u32 s39, s99, 4
    s_and_b32 s39, s39, 7
    s_mul_i32 s39, s39, 128
    s_add_u32 s39, s39, s6
    s_add_u32 m0, s7, 16384
    s_nop 0
    buffer_load_dwordx4 v10, s[40:43], s39 offen offset:0 lds
    buffer_load_dwordx4 v11, s[40:43], s39 offen offset:1024 lds
    buffer_load_dwordx4 v12, s[40:43], s39 offen offset:2048 lds
    buffer_load_dwordx4 v13, s[40:43], s39 offen offset:3072 lds
    v_mul_f32 v127, v112, v113
    v_fma_f32 v126, -v113, v113, v126
    v_fmac_f32 v127, v113, v112
    v_mul_f32 v128, v126, v126
    v_mul_f32 v129, v126, v127
    v_fma_f32 v128, -v127, v127, v128
    v_fmac_f32 v129, v127, v126
    v_mul_f32 v126, v128, v128
    v_mul_f32 v127, v128, v129
    v_fma_f32 v126, -v129, v129, v126
    v_fmac_f32 v127, v129, v128
    v_mul_f32 v116, v126, v126
    v_mul_f32 v117, v126, v127
    v_fma_f32 v116, -v127, v127, v116
    v_fmac_f32 v117, v127, v126
    v_mul_f32 v126, v116, v116
    v_mul_f32 v127, v116, v117
    v_fma_f32 v126, -v117, v117, v126
    v_fmac_f32 v127, v117, v116
    v_mul_f32 v128, v126, v126
    v_mul_f32 v129, v126, v127
    v_fma_f32 v128, -v127, v127, v128
    v_fmac_f32 v129, v127, v126
    v_mul_f32 v118, v128, v128
    v_mul_f32 v119, v128, v129
    v_fma_f32 v118, -v129, v129, v118
    v_fmac_f32 v119, v129, v128
    v_mul_f32 v120, v118, v118
    v_mul_f32 v121, v118, v119
    v_fma_f32 v120, -v119, v119, v120
    s_waitcnt vmcnt(7) lgkmcnt(0)
    s_barrier
    ds_read_b128 v[202:205], v2 offset:0
    ds_read_b128 v[198:201], v3 offset:0
    ds_read_b128 v[194:197], v4 offset:0
    ds_read_b128 v[190:193], v5 offset:0
    s_add_u32 s39, s99, 5
    s_and_b32 s39, s39, 7
    s_mul_i32 s39, s39, 176128
    s_add_u32 s39, s39, s5
    s_add_u32 m0, s82, 73728
    s_nop 0
    buffer_load_dwordx4 v14, s[48:51], s39 offen offset:0 lds
    s_add_u32 m0, s82, 74688
    s_nop 0
    buffer_load_dwordx4 v14, s[48:51], s39 offen offset:64 lds
    s_add_u32 m0, s82, 75648
    s_nop 0
    buffer_load_dwordx4 v15, s[48:51], s39 offen offset:128 lds
    s_add_u32 s39, s99, 5
    s_and_b32 s39, s39, 7
    s_mul_i32 s39, s39, 128
    s_add_u32 s39, s39, s6
    s_add_u32 m0, s7, 32768
    s_nop 0
    buffer_load_dwordx4 v10, s[40:43], s39 offen offset:0 lds
    buffer_load_dwordx4 v11, s[40:43], s39 offen offset:1024 lds
    buffer_load_dwordx4 v12, s[40:43], s39 offen offset:2048 lds
    buffer_load_dwordx4 v13, s[40:43], s39 offen offset:3072 lds
    v_fmac_f32 v121, v119, v118
    v_cmp_gt_u32 vcc, 32, v1
    s_nop 1
    v_cndmask_b32 v130, v116, 1.0, vcc
    v_cndmask_b32 v131, v117, 0, vcc
    s_bitcmp1_b32 s73, 0
    s_cselect_b64 vcc, -1, 0
    v_cndmask_b32 v126, 1.0, v126, vcc
    v_cndmask_b32 v127, 0, v127, vcc
    s_bitcmp1_b32 s73, 1
    s_cselect_b64 vcc, -1, 0
    v_cndmask_b32 v128, 1.0, v128, vcc
    v_cndmask_b32 v129, 0, v129, vcc
    v_mul_f32 v132, v130, v126
    v_mul_f32 v133, v130, v127
    v_fma_f32 v132, -v131, v127, v132
    v_fmac_f32 v133, v131, v126
    v_mul_f32 v122, v132, v128
    v_mul_f32 v123, v132, v129
    v_fma_f32 v122, -v133, v129, v122
    v_fmac_f32 v123, v133, v128
    v_mul_f32 v126, v120, v120
    v_mul_f32 v127, v120, v121
    v_fma_f32 v126, -v121, v121, v126
    v_fmac_f32 v127, v121, v120
    v_mul_f32 v128, v126, v126
    v_mul_f32 v129, v126, v127
    v_fma_f32 v128, -v127, v127, v128
    v_fmac_f32 v129, v127, v126
    v_cmp_gt_u32 vcc, 32, v1
    s_nop 1
    v_cndmask_b32 v130, v118, 1.0, vcc
    s_waitcnt vmcnt(7) lgkmcnt(0)
    s_barrier
    ds_read_b128 v[186:189], v2 offset:16384
    ds_read_b128 v[182:185], v3 offset:16384
    ds_read_b128 v[178:181], v4 offset:16384
    ds_read_b128 v[174:177], v5 offset:16384
    s_add_u32 s39, s99, 6
    s_and_b32 s39, s39, 7
    s_mul_i32 s39, s39, 176128
    s_add_u32 s39, s39, s5
    s_add_u32 m0, s82, 49152
    s_nop 0
    buffer_load_dwordx4 v14, s[48:51], s39 offen offset:0 lds
    s_add_u32 m0, s82, 50112
    s_nop 0
    buffer_load_dwordx4 v14, s[48:51], s39 offen offset:64 lds
    s_add_u32 m0, s82, 51072
    s_nop 0
    buffer_load_dwordx4 v15, s[48:51], s39 offen offset:128 lds
    s_add_u32 s39, s99, 6
    s_and_b32 s39, s39, 7
    s_mul_i32 s39, s39, 128
    s_add_u32 s39, s39, s6
    s_add_u32 m0, s7, 0
    s_nop 0
    buffer_load_dwordx4 v10, s[40:43], s39 offen offset:0 lds
    buffer_load_dwordx4 v11, s[40:43], s39 offen offset:1024 lds
    buffer_load_dwordx4 v12, s[40:43], s39 offen offset:2048 lds
    buffer_load_dwordx4 v13, s[40:43], s39 offen offset:3072 lds
    v_cndmask_b32 v131, v119, 0, vcc
    s_bitcmp1_b32 s73, 0
    s_cselect_b64 vcc, -1, 0
    v_cndmask_b32 v126, 1.0, v126, vcc
    v_cndmask_b32 v127, 0, v127, vcc
    s_bitcmp1_b32 s73, 1
    s_cselect_b64 vcc, -1, 0
    v_cndmask_b32 v128, 1.0, v128, vcc
    v_cndmask_b32 v129, 0, v129, vcc
    v_mul_f32 v132, v130, v126
    v_mul_f32 v133, v130, v127
    v_fma_f32 v132, -v131, v127, v132
    v_fmac_f32 v133, v131, v126
    v_mul_f32 v118, v132, v128
    v_mul_f32 v119, v132, v129
    v_fma_f32 v118, -v133, v129, v118
    v_fmac_f32 v119, v133, v128
    s_waitcnt vmcnt(7) lgkmcnt(0)
    s_barrier
    ds_read_b128 v[170:173], v2 offset:32768
    ds_read_b128 v[166:169], v3 offset:32768
    ds_read_b128 v[162:165], v4 offset:32768
    ds_read_b128 v[158:161], v5 offset:32768
    s_add_u32 s39, s99, 7
    s_and_b32 s39, s39, 7
    s_mul_i32 s39, s39, 176128
    s_add_u32 s39, s39, s5
    s_add_u32 m0, s82, 61440
    s_nop 0
    buffer_load_dwordx4 v14, s[48:51], s39 offen offset:0 lds
    s_add_u32 m0, s82, 62400
    s_nop 0
    buffer_load_dwordx4 v14, s[48:51], s39 offen offset:64 lds
    s_add_u32 m0, s82, 63360
    s_nop 0
    buffer_load_dwordx4 v15, s[48:51], s39 offen offset:128 lds
    s_add_u32 s39, s99, 7
    s_and_b32 s39, s39, 7
    s_mul_i32 s39, s39, 128
    s_add_u32 s39, s39, s6
    s_add_u32 m0, s7, 16384
    s_nop 0
    buffer_load_dwordx4 v10, s[40:43], s39 offen offset:0 lds
    buffer_load_dwordx4 v11, s[40:43], s39 offen offset:1024 lds
    buffer_load_dwordx4 v12, s[40:43], s39 offen offset:2048 lds
    buffer_load_dwordx4 v13, s[40:43], s39 offen offset:3072 lds
    s_lshr_b32 s31, s2, 3
    s_lshl_b32 s31, s31, 2
    s_add_u32 s31, s31, s73
    s_mul_i32 s33, s31, 6144
    s_and_b32 s31, s76, 1
    s_mul_i32 s31, s31, 720896
    s_add_u32 s33, s33, s31
    v_lshlrev_b32 v75, 10, v1
    s_mov_b64 exec, 0x3f
    buffer_load_dword v254, v75, s[52:55], s33 offen offset:384
    s_mov_b64 exec, -1
    s_waitcnt vmcnt(8) lgkmcnt(0)
    s_barrier
    ds_read_b128 v[154:157], v2 offset:0
    ds_read_b128 v[150:153], v3 offset:0
    ds_read_b128 v[146:149], v4 offset:0
    ds_read_b128 v[142:145], v5 offset:0
    s_add_u32 s39, s99, 0
    s_and_b32 s39, s39, 7
    s_mul_i32 s39, s39, 128
    s_add_u32 s39, s39, s15
    s_add_u32 m0, s34, 86016
    s_nop 0
    buffer_load_dwordx4 v16, s[44:47], s39 offen lds
    s_add_u32 s39, s39, 0x1c00
    buffer_load_dwordx4 v17, s[44:47], s39 offen offset:1024 lds
    s_add_u32 s39, s99, 1
    s_and_b32 s39, s39, 7
    s_mul_i32 s39, s39, 128
    s_add_u32 s39, s39, s15
    s_add_u32 m0, s34, 94208
    s_nop 0
    buffer_load_dwordx4 v16, s[44:47], s39 offen lds
    s_add_u32 s39, s39, 0x1c00
    buffer_load_dwordx4 v17, s[44:47], s39 offen offset:1024 lds
    s_add_u32 s39, s99, 2
    s_and_b32 s39, s39, 7
    s_mul_i32 s39, s39, 128
    s_add_u32 s39, s39, s15
    s_add_u32 m0, s34, 102400
    s_nop 0
    buffer_load_dwordx4 v16, s[44:47], s39 offen lds
    s_add_u32 s39, s39, 0x1c00
    buffer_load_dwordx4 v17, s[44:47], s39 offen offset:1024 lds
    s_add_u32 s39, s99, 3
    s_and_b32 s39, s39, 7
    s_mul_i32 s39, s39, 128
    s_add_u32 s39, s39, s15
    s_add_u32 m0, s34, 110592
    s_nop 0
    buffer_load_dwordx4 v16, s[44:47], s39 offen lds
    s_add_u32 s39, s39, 0x1c00
    buffer_load_dwordx4 v17, s[44:47], s39 offen offset:1024 lds
    s_waitcnt vmcnt(9) lgkmcnt(0)
    s_barrier
    ds_read_b128 v[138:141], v2 offset:16384
    ds_read_b128 v[134:137], v3 offset:16384
    ds_read_b128 v[130:133], v4 offset:16384
    ds_read_b128 v[126:129], v5 offset:16384
    s_add_u32 s39, s99, 4
    s_and_b32 s39, s39, 7
    s_mul_i32 s39, s39, 128
    s_add_u32 s39, s39, s15
    s_add_u32 m0, s34, 118784
    s_nop 0
    buffer_load_dwordx4 v16, s[44:47], s39 offen lds
    s_add_u32 s39, s39, 0x1c00
    buffer_load_dwordx4 v17, s[44:47], s39 offen offset:1024 lds
    s_add_u32 s39, s99, 5
    s_and_b32 s39, s39, 7
    s_mul_i32 s39, s39, 128
    s_add_u32 s39, s39, s15
    s_add_u32 m0, s34, 126976
    s_nop 0
    buffer_load_dwordx4 v16, s[44:47], s39 offen lds
    s_add_u32 s39, s39, 0x1c00
    buffer_load_dwordx4 v17, s[44:47], s39 offen offset:1024 lds
    s_add_u32 s39, s99, 6
    s_and_b32 s39, s39, 7
    s_mul_i32 s39, s39, 128
    s_add_u32 s39, s39, s15
    s_add_u32 m0, s34, 135168
    s_nop 0
    buffer_load_dwordx4 v16, s[44:47], s39 offen lds
    s_add_u32 s39, s39, 0x1c00
    buffer_load_dwordx4 v17, s[44:47], s39 offen offset:1024 lds
    s_add_u32 s39, s99, 7
    s_and_b32 s39, s39, 7
    s_mul_i32 s39, s39, 128
    s_add_u32 s39, s39, s15
    s_add_u32 m0, s34, 143360
    s_nop 0
    buffer_load_dwordx4 v16, s[44:47], s39 offen lds
    s_add_u32 s39, s39, 0x1c00
    buffer_load_dwordx4 v17, s[44:47], s39 offen offset:1024 lds
    s_waitcnt vmcnt(8) lgkmcnt(0)
    s_barrier
    ds_read_b128 v[32:35], v6 offset:0
    ds_read_b128 v[36:39], v6 offset:4096
    ds_read_b128 v[40:43], v7 offset:0
    ds_read_b128 v[44:47], v7 offset:4096
    s_waitcnt lgkmcnt(2)
    v_mfma_f32_32x32x16_bf16 v[80:95], v[250:253], v[32:35], 0
    ds_read_b128 v[48:51], v8 offset:0
    ds_read_b128 v[52:55], v8 offset:4096
    v_mfma_f32_32x32x16_bf16 v[96:111], v[250:253], v[36:39], 0
    s_waitcnt lgkmcnt(2)
    v_mfma_f32_32x32x16_bf16 v[80:95], v[246:249], v[40:43], v[80:95]
    ds_read_b128 v[32:35], v9 offset:0
    ds_read_b128 v[36:39], v9 offset:4096
    v_mfma_f32_32x32x16_bf16 v[96:111], v[246:249], v[44:47], v[96:111]
    s_waitcnt lgkmcnt(2)
    v_mfma_f32_32x32x16_bf16 v[80:95], v[242:245], v[48:51], v[80:95]
    ds_read_b128 v[40:43], v6 offset:8192
    ds_read_b128 v[44:47], v6 offset:12288
    buffer_load_dwordx2 v[250:251], v58, s[68:71], s17 offen sc1
    v_mfma_f32_32x32x16_bf16 v[96:111], v[242:245], v[52:55], v[96:111]
    s_waitcnt lgkmcnt(2)
    v_mfma_f32_32x32x16_bf16 v[80:95], v[238:241], v[32:35], v[80:95]
    ds_read_b128 v[48:51], v7 offset:8192
    ds_read_b128 v[52:55], v7 offset:12288
    v_mfma_f32_32x32x16_bf16 v[96:111], v[238:241], v[36:39], v[96:111]
    s_waitcnt lgkmcnt(2)
    v_mfma_f32_32x32x16_bf16 v[80:95], v[234:237], v[40:43], v[80:95]
    ds_read_b128 v[32:35], v8 offset:8192
    ds_read_b128 v[36:39], v8 offset:12288
    v_mfma_f32_32x32x16_bf16 v[96:111], v[234:237], v[44:47], v[96:111]
    s_waitcnt lgkmcnt(2)
    v_mfma_f32_32x32x16_bf16 v[80:95], v[230:233], v[48:51], v[80:95]
    ds_read_b128 v[40:43], v9 offset:8192
    ds_read_b128 v[44:47], v9 offset:12288
    v_mfma_f32_32x32x16_bf16 v[96:111], v[230:233], v[52:55], v[96:111]
    s_waitcnt lgkmcnt(2)
    v_mfma_f32_32x32x16_bf16 v[80:95], v[226:229], v[32:35], v[80:95]
    ds_read_b128 v[48:51], v6 offset:16384
    ds_read_b128 v[52:55], v6 offset:20480
    v_mfma_f32_32x32x16_bf16 v[96:111], v[226:229], v[36:39], v[96:111]
    s_waitcnt lgkmcnt(2)
    v_mfma_f32_32x32x16_bf16 v[80:95], v[222:225], v[40:43], v[80:95]
    ds_read_b128 v[32:35], v7 offset:16384
    ds_read_b128 v[36:39], v7 offset:20480
    v_mfma_f32_32x32x16_bf16 v[96:111], v[222:225], v[44:47], v[96:111]
    s_waitcnt lgkmcnt(2)
    v_mfma_f32_32x32x16_bf16 v[80:95], v[218:221], v[48:51], v[80:95]
    ds_read_b128 v[40:43], v8 offset:16384
    ds_read_b128 v[44:47], v8 offset:20480
    v_mfma_f32_32x32x16_bf16 v[96:111], v[218:221], v[52:55], v[96:111]
    s_waitcnt lgkmcnt(2)
    v_mfma_f32_32x32x16_bf16 v[80:95], v[214:217], v[32:35], v[80:95]
    ds_read_b128 v[48:51], v9 offset:16384
    ds_read_b128 v[52:55], v9 offset:20480
    v_mfma_f32_32x32x16_bf16 v[96:111], v[214:217], v[36:39], v[96:111]
    s_waitcnt lgkmcnt(2)
    v_mfma_f32_32x32x16_bf16 v[80:95], v[210:213], v[40:43], v[80:95]
    ds_read_b128 v[32:35], v6 offset:24576
    ds_read_b128 v[36:39], v6 offset:28672
    v_mfma_f32_32x32x16_bf16 v[96:111], v[210:213], v[44:47], v[96:111]
    s_waitcnt vmcnt(1)
    s_mov_b64 exec, 1
    ds_add_u32 v73, v74 offset:0
    s_mov_b64 exec, -1
    s_waitcnt lgkmcnt(3)
    v_mfma_f32_32x32x16_bf16 v[80:95], v[206:209], v[48:51], v[80:95]
    ds_read_b128 v[40:43], v7 offset:24576
    ds_read_b128 v[44:47], v7 offset:28672
    v_mfma_f32_32x32x16_bf16 v[96:111], v[206:209], v[52:55], v[96:111]
    s_waitcnt lgkmcnt(3)
    v_mfma_f32_32x32x16_bf16 v[80:95], v[202:205], v[32:35], v[80:95]
    ds_read_b128 v[48:51], v8 offset:24576
    ds_read_b128 v[52:55], v8 offset:28672
    v_mfma_f32_32x32x16_bf16 v[96:111], v[202:205], v[36:39], v[96:111]
    s_waitcnt lgkmcnt(2)
    v_mfma_f32_32x32x16_bf16 v[80:95], v[198:201], v[40:43], v[80:95]
    ds_read_b128 v[32:35], v9 offset:24576
    ds_read_b128 v[36:39], v9 offset:28672
    v_mfma_f32_32x32x16_bf16 v[96:111], v[198:201], v[44:47], v[96:111]
    s_waitcnt lgkmcnt(2)
    v_mfma_f32_32x32x16_bf16 v[80:95], v[194:197], v[48:51], v[80:95]
    s_mov_b32 s101, 0x1000000
L_sw_1:
    ds_read_b32 v23, v73 offset:0
    s_sub_u32 s101, s101, 1
    s_cselect_b32 s98, 0, 4
    s_waitcnt lgkmcnt(0)
    v_readfirstlane_b32 s80, v23
    s_nop 0
    s_cmp_lt_u32 s80, s98
    s_cbranch_scc1 L_sw_1
    ds_read_b128 v[40:43], v6 offset:32768
    ds_read_b128 v[44:47], v6 offset:36864
    v_mfma_f32_32x32x16_bf16 v[96:111], v[194:197], v[52:55], v[96:111]
    v_mfma_f32_32x32x16_bf16 v[80:95], v[190:193], v[32:35], v[80:95]
    ds_read_b128 v[48:51], v7 offset:32768
    ds_read_b128 v[52:55], v7 offset:36864
    v_mfma_f32_32x32x16_bf16 v[96:111], v[190:193], v[36:39], v[96:111]
    s_waitcnt lgkmcnt(2)
    v_mfma_f32_32x32x16_bf16 v[80:95], v[186:189], v[40:43], v[80:95]
    ds_read_b128 v[32:35], v8 offset:32768
    ds_read_b128 v[36:39], v8 offset:36864
    v_mfma_f32_32x32x16_bf16 v[96:111], v[186:189], v[44:47], v[96:111]
    s_waitcnt lgkmcnt(2)
    v_mfma_f32_32x32x16_bf16 v[80:95], v[182:185], v[48:51], v[80:95]
    ds_read_b128 v[40:43], v9 offset:32768
    ds_read_b128 v[44:47], v9 offset:36864
    v_mfma_f32_32x32x16_bf16 v[96:111], v[182:185], v[52:55], v[96:111]
    s_waitcnt lgkmcnt(2)
    v_mfma_f32_32x32x16_bf16 v[80:95], v[178:181], v[32:35], v[80:95]
    ds_read_b128 v[48:51], v6 offset:40960
    ds_read_b128 v[52:55], v6 offset:45056
    ds_read_b32 v28, v62
    ds_read_b128 v[224:227], v63 offset:0
    ds_read_b128 v[228:231], v63 offset:16
    ds_read_b128 v[232:235], v63 offset:32
    v_mfma_f32_32x32x16_bf16 v[96:111], v[178:181], v[36:39], v[96:111]
    ds_read_b128 v[236:239], v63 offset:48
    s_mov_b32 s83, 131072
    s_waitcnt vmcnt(0)
L_gc_2:
    v_xor_b32 v244, s78, v251
    v_cmp_ne_u32 vcc, 0, v244
    s_nop 0
    s_cmp_lg_u64 vcc, 0
    s_cbranch_scc1 L_gr_3
L_gx_4:
    s_waitcnt lgkmcnt(7)
    v_mfma_f32_32x32x16_bf16 v[80:95], v[174:177], v[40:43], v[80:95]
    ds_read_b128 v[32:35], v7 offset:40960
    ds_read_b128 v[36:39], v7 offset:45056
    v_and_b32 v244, s38, v250
    v_sub_f32 v245, v250, v244
    v_cvt_pk_bf16_f32 v64, v245, v244
    s_waitcnt lgkmcnt(6)
    v_and_b32 v76, s38, v28
    v_mfma_f32_32x32x16_bf16 v[96:111], v[174:177], v[44:47], v[96:111]
    v_cmp_gt_u32 vcc, 32, v1
    v_cvt_pk_bf16_f32 v76, -v76, -v76
    s_nop 0
    v_cndmask_b32 v76, 0, v76, vcc
    v_mov_b32 v68, v64
    v_mfma_f32_32x32x16_bf16 v[80:95], v[170:173], v[48:51], v[80:95]
    ds_read_b128 v[40:43], v8 offset:40960
    ds_read_b128 v[44:47], v8 offset:45056
    v_permlane32_swap_b32 v64, v68
    v_mfma_f32_32x32x16_bf16 v[96:111], v[170:173], v[52:55], v[96:111]
    s_waitcnt lgkmcnt(2)
    v_mfma_f32_32x32x16_bf16 v[80:95], v[166:169], v[32:35], v[80:95]
    ds_read_b128 v[48:51], v9 offset:40960
    ds_read_b128 v[52:55], v9 offset:45056
    v_mfma_f32_32x32x16_bf16 v[96:111], v[166:169], v[36:39], v[96:111]
    s_waitcnt lgkmcnt(2)
    v_mfma_f32_32x32x16_bf16 v[80:95], v[162:165], v[40:43], v[80:95]
    ds_read_b128 v[32:35], v6 offset:49152
    ds_read_b128 v[36:39], v6 offset:53248
    v_mfma_f32_32x32x16_bf16 v[96:111], v[162:165], v[44:47], v[96:111]
    s_waitcnt lgkmcnt(2)
    v_mfma_f32_32x32x16_bf16 v[80:95], v[158:161], v[48:51], v[80:95]
    ds_read_b128 v[40:43], v7 offset:49152
    ds_read_b128 v[44:47], v7 offset:53248
    v_mfma_f32_32x32x16_bf16 v[96:111], v[158:161], v[52:55], v[96:111]
    s_waitcnt lgkmcnt(2)
    v_mfma_f32_32x32x16_bf16 v[80:95], v[154:157], v[32:35], v[80:95]
    ds_read_b128 v[48:51], v8 offset:49152
    ds_read_b128 v[52:55], v8 offset:53248
    v_mfma_f32_32x32x16_bf16 v[96:111], v[154:157], v[36:39], v[96:111]
    s_waitcnt lgkmcnt(2)
    v_mfma_f32_32x32x16_bf16 v[80:95], v[150:153], v[40:43], v[80:95]
    ds_read_b128 v[32:35], v9 offset:49152
    ds_read_b128 v[36:39], v9 offset:53248
    v_mfma_f32_32x32x16_bf16 v[96:111], v[150:153], v[44:47], v[96:111]
    s_waitcnt lgkmcnt(2)
    v_mfma_f32_32x32x16_bf16 v[80:95], v[146:149], v[48:51], v[80:95]
    ds_read_b128 v[40:43], v6 offset:57344
    ds_read_b128 v[44:47], v6 offset:61440
    v_mfma_f32_32x32x16_bf16 v[96:111], v[146:149], v[52:55], v[96:111]
    s_waitcnt lgkmcnt(2)
    v_mfma_f32_32x32x16_bf16 v[80:95], v[142:145], v[32:35], v[80:95]
    ds_read_b128 v[48:51], v7 offset:57344
    ds_read_b128 v[52:55], v7 offset:61440
    v_mfma_f32_32x32x16_bf16 v[96:111], v[142:145], v[36:39], v[96:111]
    s_waitcnt lgkmcnt(2)
    v_mfma_f32_32x32x16_bf16 v[80:95], v[138:141], v[40:43], v[80:95]
    ds_read_b128 v[32:35], v8 offset:57344
    ds_read_b128 v[36:39], v8 offset:61440
    v_mfma_f32_32x32x16_bf16 v[96:111], v[138:141], v[44:47], v[96:111]
    s_waitcnt lgkmcnt(2)
    v_mfma_f32_32x32x16_bf16 v[80:95], v[134:137], v[48:51], v[80:95]
    ds_read_b128 v[40:43], v9 offset:57344
    ds_read_b128 v[44:47], v9 offset:61440
    v_mfma_f32_32x32x16_bf16 v[96:111], v[134:137], v[52:55], v[96:111]
    s_waitcnt lgkmcnt(2)
    v_mfma_f32_32x32x16_bf16 v[80:95], v[130:133], v[32:35], v[80:95]
    v_mfma_f32_32x32x16_bf16 v[96:111], v[130:133], v[36:39], v[96:111]
    s_waitcnt lgkmcnt(0)
    v_mfma_f32_32x32x16_bf16 v[80:95], v[126:129], v[40:43], v[80:95]
    v_mfma_f32_32x32x16_bf16 v[96:111], v[126:129], v[44:47], v[96:111]
    s_setprio 2
    v_mfma_f32_32x32x16_bf16 v[80:95], v[76:79], v[64:67], v[80:95]
    v_mfma_f32_32x32x16_bf16 v[96:111], v[76:79], v[68:71], v[96:111]
    s_lshl_b32 s81, s73, 14
    v_add_u32 v6, s81, v6
    v_add_u32 v7, s81, v7
    v_add_u32 v8, s81, v8
    v_add_u32 v9, s81, v9
    v_mov_b32 v34, s78
    v_mov_b32 v35, s78
    s_nop 3
    v_mul_f32 v192, v224, v80
    v_mul_f32 v193, v224, v96
    v_mul_f32 v194, v225, v81
    v_mul_f32 v195, v225, v97
    v_pk_fma_f32 v[48:49], v[112:113], v[192:193], v[194:195] op_sel:[0,0,0] op_sel_hi:[0,1,1]
    v_pk_fma_f32 v[46:47], v[112:113], v[192:193], v[48:49] op_sel:[1,1,0] op_sel_hi:[1,0,1] neg_lo:[1,0,0]
    v_mul_f32 v196, v226, v82
    v_mul_f32 v197, v226, v98
    v_pk_fma_f32 v[48:49], v[112:113], v[46:47], v[196:197] op_sel:[0,0,0] op_sel_hi:[0,1,1]
    v_pk_fma_f32 v[44:45], v[112:113], v[46:47], v[48:49] op_sel:[1,1,0] op_sel_hi:[1,0,1] neg_lo:[1,0,0]
    v_mul_f32 v198, v227, v83
    v_mul_f32 v199, v227, v99
    v_pk_fma_f32 v[48:49], v[112:113], v[44:45], v[198:199] op_sel:[0,0,0] op_sel_hi:[0,1,1]
    v_pk_fma_f32 v[46:47], v[112:113], v[44:45], v[48:49] op_sel:[1,1,0] op_sel_hi:[1,0,1] neg_lo:[1,0,0]
    v_mul_f32 v200, v228, v84
    v_mul_f32 v201, v228, v100
    v_pk_fma_f32 v[48:49], v[112:113], v[46:47], v[200:201] op_sel:[0,0,0] op_sel_hi:[0,1,1]
    v_pk_fma_f32 v[44:45], v[112:113], v[46:47], v[48:49] op_sel:[1,1,0] op_sel_hi:[1,0,1] neg_lo:[1,0,0]
    v_mul_f32 v202, v229, v85
    v_mul_f32 v203, v229, v101
    v_pk_fma_f32 v[48:49], v[112:113], v[44:45], v[202:203] op_sel:[0,0,0] op_sel_hi:[0,1,1]
    v_pk_fma_f32 v[46:47], v[112:113], v[44:45], v[48:49] op_sel:[1,1,0] op_sel_hi:[1,0,1] neg_lo:[1,0,0]
    v_mul_f32 v204, v230, v86
    v_mul_f32 v205, v230, v102
    v_pk_fma_f32 v[48:49], v[112:113], v[46:47], v[204:205] op_sel:[0,0,0] op_sel_hi:[0,1,1]
    v_pk_fma_f32 v[44:45], v[112:113], v[46:47], v[48:49] op_sel:[1,1,0] op_sel_hi:[1,0,1] neg_lo:[1,0,0]
    v_mul_f32 v206, v231, v87
    v_mul_f32 v207, v231, v103
    v_pk_fma_f32 v[48:49], v[112:113], v[44:45], v[206:207] op_sel:[0,0,0] op_sel_hi:[0,1,1]
    v_pk_fma_f32 v[46:47], v[112:113], v[44:45], v[48:49] op_sel:[1,1,0] op_sel_hi:[1,0,1] neg_lo:[1,0,0]
    v_mul_f32 v208, v232, v88
    v_mul_f32 v209, v232, v104
    v_pk_fma_f32 v[48:49], v[112:113], v[46:47], v[208:209] op_sel:[0,0,0] op_sel_hi:[0,1,1]
    v_pk_fma_f32 v[44:45], v[112:113], v[46:47], v[48:49] op_sel:[1,1,0] op_sel_hi:[1,0,1] neg_lo:[1,0,0]
    v_mul_f32 v210, v233, v89
    v_mul_f32 v211, v233, v105
    v_pk_fma_f32 v[48:49], v[112:113], v[44:45], v[210:211] op_sel:[0,0,0] op_sel_hi:[0,1,1]
    v_pk_fma_f32 v[46:47], v[112:113], v[44:45], v[48:49] op_sel:[1,1,0] op_sel_hi:[1,0,1] neg_lo:[1,0,0]
    v_mul_f32 v212, v234, v90
    v_mul_f32 v213, v234, v106
    v_pk_fma_f32 v[48:49], v[112:113], v[46:47], v[212:213] op_sel:[0,0,0] op_sel_hi:[0,1,1]
    v_pk_fma_f32 v[44:45], v[112:113], v[46:47], v[48:49] op_sel:[1,1,0] op_sel_hi:[1,0,1] neg_lo:[1,0,0]
    v_mul_f32 v214, v235, v91
    v_mul_f32 v215, v235, v107
    v_pk_fma_f32 v[48:49], v[112:113], v[44:45], v[214:215] op_sel:[0,0,0] op_sel_hi:[0,1,1]
    v_pk_fma_f32 v[46:47], v[112:113], v[44:45], v[48:49] op_sel:[1,1,0] op_sel_hi:[1,0,1] neg_lo:[1,0,0]
    v_mul_f32 v216, v236, v92
    v_mul_f32 v217, v236, v108
    v_pk_fma_f32 v[48:49], v[112:113], v[46:47], v[216:217] op_sel:[0,0,0] op_sel_hi:[0,1,1]
    v_pk_fma_f32 v[44:45], v[112:113], v[46:47], v[48:49] op_sel:[1,1,0] op_sel_hi:[1,0,1] neg_lo:[1,0,0]
    v_mul_f32 v218, v237, v93
    v_mul_f32 v219, v237, v109
    v_pk_fma_f32 v[48:49], v[112:113], v[44:45], v[218:219] op_sel:[0,0,0] op_sel_hi:[0,1,1]
    v_pk_fma_f32 v[46:47], v[112:113], v[44:45], v[48:49] op_sel:[1,1,0] op_sel_hi:[1,0,1] neg_lo:[1,0,0]
    v_mul_f32 v220, v238, v94
    v_mul_f32 v221, v238, v110
    v_pk_fma_f32 v[48:49], v[112:113], v[46:47], v[220:221] op_sel:[0,0,0] op_sel_hi:[0,1,1]
    v_pk_fma_f32 v[44:45], v[112:113], v[46:47], v[48:49] op_sel:[1,1,0] op_sel_hi:[1,0,1] neg_lo:[1,0,0]
    v_mul_f32 v222, v239, v95
    v_mul_f32 v223, v239, v111
    v_pk_fma_f32 v[48:49], v[112:113], v[44:45], v[222:223] op_sel:[0,0,0] op_sel_hi:[0,1,1]
    v_pk_fma_f32 v[46:47], v[112:113], v[44:45], v[48:49] op_sel:[1,1,0] op_sel_hi:[1,0,1] neg_lo:[1,0,0]
    ds_write_b64 v57, v[46:47]
    s_mov_b64 exec, 1
    ds_add_u32 v73, v74 offset:32
    s_mov_b64 exec, -1
    s_mov_b32 s101, 0x1000000
L_sw_5:
    ds_read_b32 v23, v73 offset:32
    s_sub_u32 s101, s101, 1
    s_cselect_b32 s98, 0, 4
    s_waitcnt lgkmcnt(0)
    v_readfirstlane_b32 s80, v23
    s_nop 0
    s_cmp_lt_u32 s80, s98
    s_cbranch_scc1 L_sw_5
    ds_read_b64 v[80:81], v56 offset:0
    ds_read_b64 v[82:83], v56 offset:256
    ds_read_b64 v[84:85], v56 offset:512
    ds_read_b64 v[86:87], v56 offset:768
    ds_read_b64 v[88:89], v56 offset:1024
    ds_read_b64 v[90:91], v56 offset:1280
    ds_read_b64 v[92:93], v56 offset:1536
    ds_read_b64 v[94:95], v56 offset:1792
    s_waitcnt lgkmcnt(6)
    v_pk_fma_f32 v[82:83], v[116:117], v[80:81], v[82:83] op_sel:[0,0,0] op_sel_hi:[0,1,1]
    v_pk_fma_f32 v[98:99], v[116:117], v[80:81], v[82:83] op_sel:[1,1,0] op_sel_hi:[1,0,1] neg_lo:[1,0,0]
    s_waitcnt lgkmcnt(5)
    v_pk_fma_f32 v[84:85], v[116:117], v[98:99], v[84:85] op_sel:[0,0,0] op_sel_hi:[0,1,1]
    v_pk_fma_f32 v[100:101], v[116:117], v[98:99], v[84:85] op_sel:[1,1,0] op_sel_hi:[1,0,1] neg_lo:[1,0,0]
    s_waitcnt lgkmcnt(4)
    v_pk_fma_f32 v[86:87], v[116:117], v[100:101], v[86:87] op_sel:[0,0,0] op_sel_hi:[0,1,1]
    v_pk_fma_f32 v[102:103], v[116:117], v[100:101], v[86:87] op_sel:[1,1,0] op_sel_hi:[1,0,1] neg_lo:[1,0,0]
    s_waitcnt lgkmcnt(3)
    v_pk_fma_f32 v[88:89], v[116:117], v[102:103], v[88:89] op_sel:[0,0,0] op_sel_hi:[0,1,1]
    v_pk_fma_f32 v[104:105], v[116:117], v[102:103], v[88:89] op_sel:[1,1,0] op_sel_hi:[1,0,1] neg_lo:[1,0,0]
    s_waitcnt lgkmcnt(2)
    v_pk_fma_f32 v[90:91], v[116:117], v[104:105], v[90:91] op_sel:[0,0,0] op_sel_hi:[0,1,1]
    v_pk_fma_f32 v[106:107], v[116:117], v[104:105], v[90:91] op_sel:[1,1,0] op_sel_hi:[1,0,1] neg_lo:[1,0,0]
    s_waitcnt lgkmcnt(1)
    v_pk_fma_f32 v[92:93], v[116:117], v[106:107], v[92:93] op_sel:[0,0,0] op_sel_hi:[0,1,1]
    v_pk_fma_f32 v[108:109], v[116:117], v[106:107], v[92:93] op_sel:[1,1,0] op_sel_hi:[1,0,1] neg_lo:[1,0,0]
    s_waitcnt lgkmcnt(0)
    v_pk_fma_f32 v[94:95], v[116:117], v[108:109], v[94:95] op_sel:[0,0,0] op_sel_hi:[0,1,1]
    v_pk_fma_f32 v[32:33], v[116:117], v[108:109], v[94:95] op_sel:[1,1,0] op_sel_hi:[1,0,1] neg_lo:[1,0,0]
    s_cmp_lg_u32 s73, 0
    s_cbranch_scc1 L_noE
    s_mov_b32 exec_hi, 0
    buffer_store_dwordx4 v[32:35], v31, s[68:71], s29 offen sc1
    s_mov_b64 exec, -1
L_noE:
    s_add_u32 m0, s35, 0
    s_add_u32 s31, s0, 0
    buffer_load_dwordx4 v16, s[56:59], s31 offen lds
    v_cmp_eq_u32 vcc, 1, v59
    s_nop 1
    v_cndmask_b32 v124, v124, v80, vcc
    v_cndmask_b32 v125, v125, v81, vcc
    v_cmp_eq_u32 vcc, 2, v59
    s_nop 1
    v_cndmask_b32 v124, v124, v98, vcc
    v_cndmask_b32 v125, v125, v99, vcc
    v_cmp_eq_u32 vcc, 3, v59
    s_nop 1
    v_cndmask_b32 v124, v124, v100, vcc
    v_cndmask_b32 v125, v125, v101, vcc
    v_cmp_eq_u32 vcc, 4, v59
    s_nop 1
    v_cndmask_b32 v124, v124, v102, vcc
    v_cndmask_b32 v125, v125, v103, vcc
    v_cmp_eq_u32 vcc, 5, v59
    s_nop 1
    v_cndmask_b32 v124, v124, v104, vcc
    v_cndmask_b32 v125, v125, v105, vcc
    v_cmp_eq_u32 vcc, 6, v59
    s_add_u32 m0, s35, 1024
    s_add_u32 s31, s0, 8192
    buffer_load_dwordx4 v17, s[56:59], s31 offen lds
    v_cndmask_b32 v124, v124, v106, vcc
    v_cndmask_b32 v125, v125, v107, vcc
    v_cmp_eq_u32 vcc, 7, v59
    s_nop 1
    v_cndmask_b32 v124, v124, v108, vcc
    v_cndmask_b32 v125, v125, v109, vcc
    v_mul_f32 v44, v115, v193
    v_mul_f32 v193, v114, v193
    v_fmac_f32 v193, v115, v192
    v_fma_f32 v192, v114, v192, -v44
    v_mul_f32 v44, v115, v195
    v_mul_f32 v195, v114, v195
    v_fmac_f32 v195, v115, v194
    v_fma_f32 v194, v114, v194, -v44
    v_mul_f32 v44, v115, v197
    v_mul_f32 v197, v114, v197
    v_fmac_f32 v197, v115, v196
    s_add_u32 m0, s35, 2048
    s_add_u32 s31, s0, 16384
    buffer_load_dwordx4 v16, s[56:59], s31 offen lds
    v_fma_f32 v196, v114, v196, -v44
    v_mul_f32 v44, v115, v199
    v_mul_f32 v199, v114, v199
    v_fmac_f32 v199, v115, v198
    v_fma_f32 v198, v114, v198, -v44
    v_mul_f32 v44, v115, v201
    v_mul_f32 v201, v114, v201
    v_fmac_f32 v201, v115, v200
    v_fma_f32 v200, v114, v200, -v44
    v_mul_f32 v44, v115, v203
    v_mul_f32 v203, v114, v203
    v_fmac_f32 v203, v115, v202
    v_fma_f32 v202, v114, v202, -v44
    v_mul_f32 v44, v115, v205
    v_mul_f32 v205, v114, v205
    v_fmac_f32 v205, v115, v204
    s_add_u32 m0, s35, 3072
    s_add_u32 s31, s0, 24576
    buffer_load_dwordx4 v17, s[56:59], s31 offen lds
    v_fma_f32 v204, v114, v204, -v44
    v_mul_f32 v44, v115, v207
    v_mul_f32 v207, v114, v207
    v_fmac_f32 v207, v115, v206
    v_fma_f32 v206, v114, v206, -v44
    v_mul_f32 v44, v115, v209
    v_mul_f32 v209, v114, v209
    v_fmac_f32 v209, v115, v208
    v_fma_f32 v208, v114, v208, -v44
    v_mul_f32 v44, v115, v211
    v_mul_f32 v211, v114, v211
    v_fmac_f32 v211, v115, v210
    v_fma_f32 v210, v114, v210, -v44
    v_mul_f32 v44, v115, v213
    v_mul_f32 v213, v114, v213
    v_fmac_f32 v213, v115, v212
    s_add_u32 m0, s35, 4096
    s_add_u32 s31, s0, 32768
    buffer_load_dwordx4 v16, s[56:59], s31 offen lds
    v_fma_f32 v212, v114, v212, -v44
    v_mul_f32 v44, v115, v215
    v_mul_f32 v215, v114, v215
    v_fmac_f32 v215, v115, v214
    v_fma_f32 v214, v114, v214, -v44
    v_mul_f32 v44, v115, v217
    v_mul_f32 v217, v114, v217
    v_fmac_f32 v217, v115, v216
    v_fma_f32 v216, v114, v216, -v44
    v_mul_f32 v44, v115, v219
    v_mul_f32 v219, v114, v219
    v_fmac_f32 v219, v115, v218
    v_fma_f32 v218, v114, v218, -v44
    v_mul_f32 v44, v115, v221
    v_mul_f32 v221, v114, v221
    v_fmac_f32 v221, v115, v220
    s_add_u32 m0, s35, 5120
    s_add_u32 s31, s0, 40960
    buffer_load_dwordx4 v17, s[56:59], s31 offen lds
    v_fma_f32 v220, v114, v220, -v44
    v_mul_f32 v44, v115, v223
    v_mul_f32 v223, v114, v223
    v_fmac_f32 v223, v115, v222
    v_fma_f32 v222, v114, v222, -v44
    s_add_u32 m0, s35, 6144
    s_add_u32 s31, s0, 49152
    buffer_load_dwordx4 v16, s[56:59], s31 offen lds
    s_add_u32 m0, s35, 7168
    s_add_u32 s31, s0, 57344
    buffer_load_dwordx4 v17, s[56:59], s31 offen lds
    s_add_u32 m0, s35, 8192
    s_add_u32 s31, s0, 0
    buffer_load_dwordx4 v16, s[60:63], s31 offen lds
    s_waitcnt vmcnt(8)
    s_add_u32 m0, s35, 9216
    s_add_u32 s31, s0, 8192
    buffer_load_dwordx4 v17, s[60:63], s31 offen lds
    s_waitcnt vmcnt(8)
    s_add_u32 m0, s35, 10240
    s_add_u32 s31, s0, 16384
    buffer_load_dwordx4 v16, s[60:63], s31 offen lds
    s_waitcnt vmcnt(8)
    s_add_u32 m0, s35, 11264
    s_add_u32 s31, s0, 24576
    buffer_load_dwordx4 v17, s[60:63], s31 offen lds
    s_waitcnt vmcnt(8)
    s_add_u32 m0, s35, 12288
    s_add_u32 s31, s0, 32768
    buffer_load_dwordx4 v16, s[60:63], s31 offen lds
    s_waitcnt vmcnt(8)
    s_add_u32 m0, s35, 13312
    s_add_u32 s31, s0, 40960
    buffer_load_dwordx4 v17, s[60:63], s31 offen lds
    s_waitcnt vmcnt(8)
    s_add_u32 m0, s35, 14336
    s_add_u32 s31, s0, 49152
    buffer_load_dwordx4 v16, s[60:63], s31 offen lds
    s_waitcnt vmcnt(8)
    s_add_u32 m0, s35, 15360
    s_add_u32 s31, s0, 57344
    buffer_load_dwordx4 v17, s[60:63], s31 offen lds
    s_mov_b32 s83, 131072
    buffer_load_dwordx4 v[80:83], v18, s[68:71], s28 offen sc1
    buffer_load_dwordx4 v[84:87], v19, s[68:71], s28 offen sc1
    s_waitcnt vmcnt(0)
L_lb_6:
    s_mov_b64 s[32:33], 0
    v_cmp_ne_u32 vcc, s78, v82
    v_cmp_le_i32 s[8:9], 0, v72
    s_nop 0
    s_and_b64 vcc, vcc, s[8:9]
    s_or_b64 s[32:33], s[32:33], vcc
    v_cmp_ne_u32 vcc, s78, v86
    v_cmp_le_i32 s[8:9], 2, v72
    s_nop 0
    s_and_b64 vcc, vcc, s[8:9]
    s_or_b64 s[32:33], s[32:33], vcc
    s_cbranch_scc1 L_lbr_8
L_lbd_7:
    v_pk_fma_f32 v[80:81], v[120:121], v[84:85], v[80:81] op_sel:[0,0,0] op_sel_hi:[0,1,1]
    v_pk_fma_f32 v[80:81], v[120:121], v[84:85], v[80:81] op_sel:[1,1,0] op_sel_hi:[1,0,1] neg_lo:[1,0,0]
    v_mul_f32 v88, v118, v80
    v_mul_f32 v89, v118, v81
    v_fma_f32 v88, -v119, v81, v88
    v_fmac_f32 v89, v119, v80
    ds_write_b64 v57, v[88:89] offset:2048
    s_mov_b64 exec, 1
    ds_add_u32 v73, v74 offset:20
    s_mov_b64 exec, -1
    ds_read_b128 v[144:147], v6 offset:8192
    ds_read_b128 v[148:151], v6 offset:12288
    ds_read_b128 v[152:155], v7 offset:8192
    ds_read_b128 v[156:159], v7 offset:12288
    ds_read_b128 v[176:179], v8 offset:8192
    ds_read_b128 v[180:183], v8 offset:12288
    ds_read_b128 v[184:187], v9 offset:8192
    ds_read_b128 v[188:191], v9 offset:12288
    ds_read_b128 v[128:131], v6 offset:0
    ds_read_b128 v[132:135], v6 offset:4096
    ds_read_b128 v[136:139], v7 offset:0
    ds_read_b128 v[140:143], v7 offset:4096
    ds_read_b128 v[160:163], v8 offset:0
    ds_read_b128 v[164:167], v8 offset:4096
    ds_read_b128 v[168:171], v9 offset:0
    ds_read_b128 v[172:175], v9 offset:4096
    s_waitcnt lgkmcnt(0)
    s_add_u32 m0, s35, 0
    s_add_u32 s31, s1, 0
    buffer_load_dwordx4 v16, s[56:59], s31 offen lds
    s_add_u32 m0, s35, 1024
    s_add_u32 s31, s1, 8192
    buffer_load_dwordx4 v17, s[56:59], s31 offen lds
    s_add_u32 m0, s35, 2048
    s_add_u32 s31, s1, 16384
    buffer_load_dwordx4 v16, s[56:59], s31 offen lds
    s_add_u32 m0, s35, 3072
    s_add_u32 s31, s1, 24576
    buffer_load_dwordx4 v17, s[56:59], s31 offen lds
    s_add_u32 m0, s35, 4096
    s_add_u32 s31, s1, 32768
    buffer_load_dwordx4 v16, s[56:59], s31 offen lds
    s_add_u32 m0, s35, 5120
    s_add_u32 s31, s1, 40960
    buffer_load_dwordx4 v17, s[56:59], s31 offen lds
    s_mov_b32 s101, 0x1000000
L_sw_9:
    ds_read_b32 v23, v73 offset:20
    s_sub_u32 s101, s101, 1
    s_cselect_b32 s98, 0, 4
    s_waitcnt lgkmcnt(0)
    v_readfirstlane_b32 s80, v23
    s_nop 0
    s_cmp_lt_u32 s80, s98
    s_cbranch_scc1 L_sw_9
    ds_read_b64 v[92:93], v56 offset:2048
    ds_read_b64 v[94:95], v56 offset:2304
    ds_read_b64 v[96:97], v56 offset:2560
    ds_read_b64 v[98:99], v56 offset:2816
    ds_read_b64 v[100:101], v56 offset:3072
    ds_read_b64 v[102:103], v56 offset:3328
    ds_read_b64 v[104:105], v56 offset:3584
    ds_read_b64 v[106:107], v56 offset:3840
    s_waitcnt lgkmcnt(6)
    v_add_f32 v92, v92, v94
    v_add_f32 v93, v93, v95
    s_waitcnt lgkmcnt(4)
    v_add_f32 v96, v96, v98
    v_add_f32 v97, v97, v99
    s_waitcnt lgkmcnt(2)
    v_add_f32 v100, v100, v102
    v_add_f32 v101, v101, v103
    s_waitcnt lgkmcnt(0)
    v_add_f32 v104, v104, v106
    v_add_f32 v105, v105, v107
    v_add_f32 v92, v92, v96
    v_add_f32 v93, v93, v97
    v_add_f32 v100, v100, v104
    v_add_f32 v101, v101, v105
    v_add_f32 v88, v92, v100
    v_add_f32 v89, v93, v101
    v_pk_fma_f32 v[90:91], v[122:123], v[88:89], v[124:125] op_sel:[0,0,0] op_sel_hi:[0,1,1]
    v_pk_fma_f32 v[90:91], v[122:123], v[88:89], v[90:91] op_sel:[1,1,0] op_sel_hi:[1,0,1] neg_lo:[1,0,0]
    v_mul_f32 v92, v114, v90
    v_mul_f32 v93, v114, v91
    v_fma_f32 v92, -v115, v91, v92
    v_fmac_f32 v93, v115, v90
    v_pk_fma_f32 v[192:193], v[112:113], v[92:93], v[192:193] op_sel:[0,0,0] op_sel_hi:[0,1,1]
    v_pk_fma_f32 v[192:193], v[112:113], v[92:93], v[192:193] op_sel:[1,1,0] op_sel_hi:[1,0,1] neg_lo:[1,0,0]
    v_pk_fma_f32 v[194:195], v[112:113], v[192:193], v[194:195] op_sel:[0,0,0] op_sel_hi:[0,1,1]
    v_pk_fma_f32 v[194:195], v[112:113], v[192:193], v[194:195] op_sel:[1,1,0] op_sel_hi:[1,0,1] neg_lo:[1,0,0]
    v_cvt_pk_bf16_f32 v224, v192, v194
    v_cvt_pk_bf16_f32 v232, -v193, -v195
    v_pk_fma_f32 v[196:197], v[112:113], v[194:195], v[196:197] op_sel:[0,0,0] op_sel_hi:[0,1,1]
    v_pk_fma_f32 v[196:197], v[112:113], v[194:195], v[196:197] op_sel:[1,1,0] op_sel_hi:[1,0,1] neg_lo:[1,0,0]
    v_pk_fma_f32 v[198:199], v[112:113], v[196:197], v[198:199] op_sel:[0,0,0] op_sel_hi:[0,1,1]
    v_pk_fma_f32 v[198:199], v[112:113], v[196:197], v[198:199] op_sel:[1,1,0] op_sel_hi:[1,0,1] neg_lo:[1,0,0]
    v_cvt_pk_bf16_f32 v225, v196, v198
    v_cvt_pk_bf16_f32 v233, -v197, -v199
    v_pk_fma_f32 v[200:201], v[112:113], v[198:199], v[200:201] op_sel:[0,0,0] op_sel_hi:[0,1,1]
    v_pk_fma_f32 v[200:201], v[112:113], v[198:199], v[200:201] op_sel:[1,1,0] op_sel_hi:[1,0,1] neg_lo:[1,0,0]
    v_pk_fma_f32 v[202:203], v[112:113], v[200:201], v[202:203] op_sel:[0,0,0] op_sel_hi:[0,1,1]
    v_pk_fma_f32 v[202:203], v[112:113], v[200:201], v[202:203] op_sel:[1,1,0] op_sel_hi:[1,0,1] neg_lo:[1,0,0]
    v_cvt_pk_bf16_f32 v226, v200, v202
    v_cvt_pk_bf16_f32 v234, -v201, -v203
    v_pk_fma_f32 v[204:205], v[112:113], v[202:203], v[204:205] op_sel:[0,0,0] op_sel_hi:[0,1,1]
    v_pk_fma_f32 v[204:205], v[112:113], v[202:203], v[204:205] op_sel:[1,1,0] op_sel_hi:[1,0,1] neg_lo:[1,0,0]
    v_pk_fma_f32 v[206:207], v[112:113], v[204:205], v[206:207] op_sel:[0,0,0] op_sel_hi:[0,1,1]
    v_pk_fma_f32 v[206:207], v[112:113], v[204:205], v[206:207] op_sel:[1,1,0] op_sel_hi:[1,0,1] neg_lo:[1,0,0]
    v_cvt_pk_bf16_f32 v227, v204, v206
    v_cvt_pk_bf16_f32 v235, -v205, -v207
    ds_write_b128 v60, v[224:227] offset:12288
    ds_write_b128 v60, v[232:235] offset:14336
    v_pk_fma_f32 v[208:209], v[112:113], v[206:207], v[208:209] op_sel:[0,0,0] op_sel_hi:[0,1,1]
    v_pk_fma_f32 v[208:209], v[112:113], v[206:207], v[208:209] op_sel:[1,1,0] op_sel_hi:[1,0,1] neg_lo:[1,0,0]
    v_pk_fma_f32 v[210:211], v[112:113], v[208:209], v[210:211] op_sel:[0,0,0] op_sel_hi:[0,1,1]
    v_pk_fma_f32 v[210:211], v[112:113], v[208:209], v[210:211] op_sel:[1,1,0] op_sel_hi:[1,0,1] neg_lo:[1,0,0]
    v_cvt_pk_bf16_f32 v228, v208, v210
    v_cvt_pk_bf16_f32 v236, -v209, -v211
    v_pk_fma_f32 v[212:213], v[112:113], v[210:211], v[212:213] op_sel:[0,0,0] op_sel_hi:[0,1,1]
    v_pk_fma_f32 v[212:213], v[112:113], v[210:211], v[212:213] op_sel:[1,1,0] op_sel_hi:[1,0,1] neg_lo:[1,0,0]
    v_pk_fma_f32 v[214:215], v[112:113], v[212:213], v[214:215] op_sel:[0,0,0] op_sel_hi:[0,1,1]
    v_pk_fma_f32 v[214:215], v[112:113], v[212:213], v[214:215] op_sel:[1,1,0] op_sel_hi:[1,0,1] neg_lo:[1,0,0]
    v_cvt_pk_bf16_f32 v229, v212, v214
    v_cvt_pk_bf16_f32 v237, -v213, -v215
    v_pk_fma_f32 v[216:217], v[112:113], v[214:215], v[216:217] op_sel:[0,0,0] op_sel_hi:[0,1,1]
    v_pk_fma_f32 v[216:217], v[112:113], v[214:215], v[216:217] op_sel:[1,1,0] op_sel_hi:[1,0,1] neg_lo:[1,0,0]
    v_pk_fma_f32 v[218:219], v[112:113], v[216:217], v[218:219] op_sel:[0,0,0] op_sel_hi:[0,1,1]
    v_pk_fma_f32 v[218:219], v[112:113], v[216:217], v[218:219] op_sel:[1,1,0] op_sel_hi:[1,0,1] neg_lo:[1,0,0]
    v_cvt_pk_bf16_f32 v230, v216, v218
    v_cvt_pk_bf16_f32 v238, -v217, -v219
    v_pk_fma_f32 v[220:221], v[112:113], v[218:219], v[220:221] op_sel:[0,0,0] op_sel_hi:[0,1,1]
    v_pk_fma_f32 v[220:221], v[112:113], v[218:219], v[220:221] op_sel:[1,1,0] op_sel_hi:[1,0,1] neg_lo:[1,0,0]
    v_pk_fma_f32 v[222:223], v[112:113], v[220:221], v[222:223] op_sel:[0,0,0] op_sel_hi:[0,1,1]
    v_pk_fma_f32 v[222:223], v[112:113], v[220:221], v[222:223] op_sel:[1,1,0] op_sel_hi:[1,0,1] neg_lo:[1,0,0]
    v_cvt_pk_bf16_f32 v231, v220, v222
    v_cvt_pk_bf16_f32 v239, -v221, -v223
    ds_write_b128 v60, v[228:231] offset:12304
    ds_write_b128 v60, v[236:239] offset:14352
    ds_read_b64_tr_b16 v[96:97], v61 offset:12288
    ds_read_b64_tr_b16 v[98:99], v61 offset:12544
    ds_read_b64_tr_b16 v[100:101], v61 offset:13312
    ds_read_b64_tr_b16 v[102:103], v61 offset:13568
    ds_read_b64_tr_b16 v[104:105], v61 offset:14336
    ds_read_b64_tr_b16 v[106:107], v61 offset:14592
    ds_read_b64_tr_b16 v[108:109], v61 offset:15360
    ds_read_b64_tr_b16 v[110:111], v61 offset:15616
    s_waitcnt lgkmcnt(6)
    buffer_store_dwordx4 v[96:99], v31, s[68:71], s30 offen offset:0 sc1
    s_waitcnt lgkmcnt(4)
    buffer_store_dwordx4 v[100:103], v31, s[68:71], s30 offen offset:1024 sc1
    s_waitcnt lgkmcnt(2)
    buffer_store_dwordx4 v[104:107], v31, s[68:71], s30 offen offset:2048 sc1
    s_waitcnt lgkmcnt(0)
    buffer_store_dwordx4 v[108:111], v31, s[68:71], s30 offen offset:3072 sc1
    s_add_u32 m0, s35, 6144
    s_add_u32 s31, s1, 49152
    buffer_load_dwordx4 v16, s[56:59], s31 offen lds
    s_add_u32 m0, s35, 7168
    s_add_u32 s31, s1, 57344
    buffer_load_dwordx4 v17, s[56:59], s31 offen lds
    s_add_u32 m0, s35, 8192
    s_add_u32 s31, s1, 0
    buffer_load_dwordx4 v16, s[60:63], s31 offen lds
    s_add_u32 m0, s35, 9216
    s_add_u32 s31, s1, 8192
    buffer_load_dwordx4 v17, s[60:63], s31 offen lds
    s_waitcnt vmcnt(4)
    s_waitcnt lgkmcnt(0)
    s_mov_b32 s33, s78
    s_atomic_swap s33, s[26:27], 0x0
    s_setprio 0
    s_add_u32 m0, s35, 10240
    s_add_u32 s31, s1, 16384
    buffer_load_dwordx4 v16, s[60:63], s31 offen lds
    s_add_u32 m0, s35, 11264
    s_add_u32 s31, s1, 24576
    buffer_load_dwordx4 v17, s[60:63], s31 offen lds
    s_add_u32 m0, s35, 12288
    s_add_u32 s31, s1, 32768
    buffer_load_dwordx4 v16, s[60:63], s31 offen lds
    s_add_u32 m0, s35, 13312
    s_add_u32 s31, s1, 40960
    buffer_load_dwordx4 v17, s[60:63], s31 offen lds
    s_add_u32 m0, s35, 14336
    s_add_u32 s31, s1, 49152
    buffer_load_dwordx4 v16, s[60:63], s31 offen lds
    s_waitcnt vmcnt(8)
    s_add_u32 m0, s35, 15360
    s_add_u32 s31, s1, 57344
    buffer_load_dwordx4 v17, s[60:63], s31 offen lds
    v_lshlrev_b32 v2, 4, v1
    v_add_u32 v3, 155648, v2
    s_mul_i32 s3, s76, 311296
    s_lshl_b32 s82, s73, 14
    s_add_u32 s3, s3, s82
    s_add_u32 s3, s3, 5332992
    s_mov_b32 s83, 131072
L_dp_10:
    s_load_dwordx2 s[8:9], s[20:21], 0 glc
    s_load_dwordx2 s[10:11], s[20:21], 128 glc
    s_load_dwordx2 s[12:13], s[20:21], 256 glc
    s_load_dwordx2 s[14:15], s[20:21], 384 glc
    s_waitcnt lgkmcnt(0)
L_dchk:
    s_mov_b32 s16, 0
    s_cmp_eq_u64 s[8:9], s[78:79]
    s_cselect_b32 s17, 17, 0
    s_or_b32 s16, s16, s17
    s_cmp_eq_u64 s[10:11], s[78:79]
    s_cselect_b32 s17, 34, 0
    s_or_b32 s16, s16, s17
    s_cmp_eq_u64 s[12:13], s[78:79]
    s_cselect_b32 s17, 68, 0
    s_or_b32 s16, s16, s17
    s_cmp_eq_u64 s[14:15], s[78:79]
    s_cselect_b32 s17, 136, 0
    s_or_b32 s16, s16, s17
    s_lshr_b32 s17, s16, 1
    s_and_b32 s17, s17, s16
    s_lshr_b32 s18, s16, 2
    s_and_b32 s18, s18, s17
    s_and_b32 s18, s18, 15
    s_cbranch_scc1 L_dg_11
    s_sleep 2
    s_sub_u32 s83, s83, 1
    s_cmp_lg_u32 s83, 0
    s_cbranch_scc1 L_dp_10
    s_mov_b32 s18, 1
L_dg_11:
    s_bitcmp0_b32 s18, 0
    s_cbranch_scc1 L_rotsel
    s_add_u32 s39, s3, 0
    buffer_load_dwordx4 v[16:19], v2, s[68:71], s39 offen sc1
    buffer_load_dwordx4 v[20:23], v3, s[68:71], s39 offen sc1
    s_add_u32 s39, s3, 1024
    buffer_load_dwordx4 v[24:27], v2, s[68:71], s39 offen sc1
    buffer_load_dwordx4 v[28:31], v3, s[68:71], s39 offen sc1
    s_add_u32 s39, s3, 2048
    buffer_load_dwordx4 v[32:35], v2, s[68:71], s39 offen sc1
    buffer_load_dwordx4 v[36:39], v3, s[68:71], s39 offen sc1
    s_add_u32 s39, s3, 3072
    buffer_load_dwordx4 v[40:43], v2, s[68:71], s39 offen sc1
    buffer_load_dwordx4 v[44:47], v3, s[68:71], s39 offen sc1
    s_add_u32 s39, s3, 4096
    buffer_load_dwordx4 v[48:51], v2, s[68:71], s39 offen sc1
    buffer_load_dwordx4 v[52:55], v3, s[68:71], s39 offen sc1
    s_waitcnt vmcnt(10)
    ds_read_b128 v[192:195], v6 offset:0
    ds_read_b128 v[196:199], v6 offset:4096
    ds_read_b128 v[200:203], v7 offset:0
    ds_read_b128 v[204:207], v7 offset:4096
    ds_read_b128 v[208:211], v6 offset:8192
    ds_read_b128 v[212:215], v6 offset:12288
    ds_read_b128 v[216:219], v7 offset:8192
    ds_read_b128 v[220:223], v7 offset:12288
    ds_read_b128 v[224:227], v8 offset:0
    ds_read_b128 v[228:231], v8 offset:4096
    ds_read_b128 v[232:235], v9 offset:0
    ds_read_b128 v[236:239], v9 offset:4096
    ds_read_b128 v[240:243], v8 offset:8192
    ds_read_b128 v[244:247], v8 offset:12288
    ds_read_b128 v[248:251], v9 offset:8192
    ds_read_b128 v[252:255], v9 offset:12288
    s_waitcnt lgkmcnt(0)
    v_lshrrev_b32 v5, 5, v1
    v_and_b32 v6, 7, v1
    v_and_b32 v4, 31, v1
    v_xor_b32 v5, v5, v6
    v_lshlrev_b32 v5, 4, v5
    v_lshl_add_u32 v4, v4, 7, v5
    v_add_u32 v4, s35, v4
    v_xor_b32 v5, 32, v4
    v_xor_b32 v6, 64, v4
    v_xor_b32 v7, 0x60, v4
    v_mov_b32 v8, 160768
    v_mov_b32 v9, 1
    s_waitcnt vmcnt(9)
    v_mfma_f32_32x32x16_bf16 v[64:79], v[128:131], v[16:19], 0
    v_mfma_f32_32x32x16_bf16 v[96:111], v[132:135], v[16:19], 0
    s_add_u32 s39, s3, 5120
    buffer_load_dwordx4 v[16:19], v2, s[68:71], s39 offen sc1
    s_waitcnt vmcnt(9)
    v_mfma_f32_32x32x16_bf16 v[80:95], v[128:131], v[20:23], 0
    v_mfma_f32_32x32x16_bf16 v[112:127], v[132:135], v[20:23], 0
    buffer_load_dwordx4 v[20:23], v3, s[68:71], s39 offen sc1
    s_waitcnt vmcnt(9)
    v_mfma_f32_32x32x16_bf16 v[64:79], v[136:139], v[24:27], v[64:79]
    v_mfma_f32_32x32x16_bf16 v[96:111], v[140:143], v[24:27], v[96:111]
    s_add_u32 s39, s3, 6144
    buffer_load_dwordx4 v[24:27], v2, s[68:71], s39 offen sc1
    s_waitcnt vmcnt(9)
    v_mfma_f32_32x32x16_bf16 v[80:95], v[136:139], v[28:31], v[80:95]
    v_mfma_f32_32x32x16_bf16 v[112:127], v[140:143], v[28:31], v[112:127]
    buffer_load_dwordx4 v[28:31], v3, s[68:71], s39 offen sc1
    s_waitcnt vmcnt(9)
    v_mfma_f32_32x32x16_bf16 v[64:79], v[144:147], v[32:35], v[64:79]
    v_mfma_f32_32x32x16_bf16 v[96:111], v[148:151], v[32:35], v[96:111]
    s_add_u32 s39, s3, 7168
    buffer_load_dwordx4 v[32:35], v2, s[68:71], s39 offen sc1
    s_waitcnt vmcnt(9)
    v_mfma_f32_32x32x16_bf16 v[80:95], v[144:147], v[36:39], v[80:95]
    v_mfma_f32_32x32x16_bf16 v[112:127], v[148:151], v[36:39], v[112:127]
    buffer_load_dwordx4 v[36:39], v3, s[68:71], s39 offen sc1
    s_waitcnt vmcnt(9)
    v_mfma_f32_32x32x16_bf16 v[64:79], v[152:155], v[40:43], v[64:79]
    v_mfma_f32_32x32x16_bf16 v[96:111], v[156:159], v[40:43], v[96:111]
    s_add_u32 s39, s3, 8192
    buffer_load_dwordx4 v[40:43], v2, s[68:71], s39 offen sc1
    s_waitcnt vmcnt(9)
    v_mfma_f32_32x32x16_bf16 v[80:95], v[152:155], v[44:47], v[80:95]
    v_mfma_f32_32x32x16_bf16 v[112:127], v[156:159], v[44:47], v[112:127]
    s_add_u32 s39, s3, 9216
    buffer_load_dwordx4 v[44:47], v2, s[68:71], s39 offen sc1
    s_waitcnt vmcnt(9)
    v_mfma_f32_32x32x16_bf16 v[64:79], v[160:163], v[48:51], v[64:79]
    v_mfma_f32_32x32x16_bf16 v[96:111], v[164:167], v[48:51], v[96:111]
    s_add_u32 s39, s3, 10240
    buffer_load_dwordx4 v[48:51], v2, s[68:71], s39 offen sc1
    s_waitcnt vmcnt(9)
    v_mfma_f32_32x32x16_bf16 v[80:95], v[160:163], v[52:55], v[80:95]
    v_mfma_f32_32x32x16_bf16 v[112:127], v[164:167], v[52:55], v[112:127]
    s_add_u32 s39, s3, 11264
    buffer_load_dwordx4 v[52:55], v2, s[68:71], s39 offen sc1
    s_waitcnt vmcnt(9)
    v_mfma_f32_32x32x16_bf16 v[64:79], v[168:171], v[16:19], v[64:79]
    v_mfma_f32_32x32x16_bf16 v[96:111], v[172:175], v[16:19], v[96:111]
    s_bitcmp0_b32 s16, 3
    s_cbranch_scc1 L_nw_12
L_nb_13:
    s_add_u32 s39, s3, 12288
    buffer_load_dwordx4 v[16:19], v2, s[68:71], s39 offen sc1
    s_waitcnt vmcnt(9)
    v_mfma_f32_32x32x16_bf16 v[80:95], v[168:171], v[20:23], v[80:95]
    v_mfma_f32_32x32x16_bf16 v[112:127], v[172:175], v[20:23], v[112:127]
    s_add_u32 s39, s3, 13312
    buffer_load_dwordx4 v[20:23], v2, s[68:71], s39 offen sc1
    s_waitcnt vmcnt(9)
    v_mfma_f32_32x32x16_bf16 v[64:79], v[176:179], v[24:27], v[64:79]
    v_mfma_f32_32x32x16_bf16 v[96:111], v[180:183], v[24:27], v[96:111]
    s_add_u32 s39, s3, 14336
    buffer_load_dwordx4 v[24:27], v2, s[68:71], s39 offen sc1
    s_waitcnt vmcnt(9)
    v_mfma_f32_32x32x16_bf16 v[80:95], v[176:179], v[28:31], v[80:95]
    v_mfma_f32_32x32x16_bf16 v[112:127], v[180:183], v[28:31], v[112:127]
    s_add_u32 s39, s3, 15360
    buffer_load_dwordx4 v[28:31], v2, s[68:71], s39 offen sc1
    s_waitcnt vmcnt(9)
    v_mfma_f32_32x32x16_bf16 v[64:79], v[184:187], v[32:35], v[64:79]
    v_mfma_f32_32x32x16_bf16 v[96:111], v[188:191], v[32:35], v[96:111]
    s_add_u32 s39, s3, 8192
    buffer_load_dwordx4 v[32:35], v3, s[68:71], s39 offen sc1
    s_waitcnt vmcnt(9)
    v_mfma_f32_32x32x16_bf16 v[80:95], v[184:187], v[36:39], v[80:95]
    v_mfma_f32_32x32x16_bf16 v[112:127], v[188:191], v[36:39], v[112:127]
    s_add_u32 s39, s3, 9216
    buffer_load_dwordx4 v[36:39], v3, s[68:71], s39 offen sc1
    s_waitcnt vmcnt(9)
    v_mfma_f32_32x32x16_bf16 v[64:79], v[192:195], v[40:43], v[64:79]
    v_mfma_f32_32x32x16_bf16 v[96:111], v[196:199], v[40:43], v[96:111]
    s_add_u32 s39, s3, 10240
    buffer_load_dwordx4 v[40:43], v3, s[68:71], s39 offen sc1
    s_waitcnt vmcnt(9)
    v_mfma_f32_32x32x16_bf16 v[64:79], v[200:203], v[44:47], v[64:79]
    v_mfma_f32_32x32x16_bf16 v[96:111], v[204:207], v[44:47], v[96:111]
    s_add_u32 s39, s3, 11264
    buffer_load_dwordx4 v[44:47], v3, s[68:71], s39 offen sc1
    s_waitcnt vmcnt(9)
    v_mfma_f32_32x32x16_bf16 v[64:79], v[208:211], v[48:51], v[64:79]
    v_mfma_f32_32x32x16_bf16 v[96:111], v[212:215], v[48:51], v[96:111]
    s_add_u32 s39, s3, 12288
    buffer_load_dwordx4 v[48:51], v3, s[68:71], s39 offen sc1
    s_waitcnt vmcnt(9)
    v_mfma_f32_32x32x16_bf16 v[64:79], v[216:219], v[52:55], v[64:79]
    v_mfma_f32_32x32x16_bf16 v[96:111], v[220:223], v[52:55], v[96:111]
    s_add_u32 s39, s3, 13312
    buffer_load_dwordx4 v[52:55], v3, s[68:71], s39 offen sc1
    s_waitcnt vmcnt(9)
    v_mfma_f32_32x32x16_bf16 v[64:79], v[224:227], v[16:19], v[64:79]
    v_mfma_f32_32x32x16_bf16 v[96:111], v[228:231], v[16:19], v[96:111]
    s_add_u32 s39, s3, 14336
    buffer_load_dwordx4 v[16:19], v3, s[68:71], s39 offen sc1
    s_waitcnt vmcnt(9)
    v_mfma_f32_32x32x16_bf16 v[64:79], v[232:235], v[20:23], v[64:79]
    v_mfma_f32_32x32x16_bf16 v[96:111], v[236:239], v[20:23], v[96:111]
    s_add_u32 s39, s3, 15360
    buffer_load_dwordx4 v[20:23], v3, s[68:71], s39 offen sc1
    s_waitcnt vmcnt(9)
    v_mfma_f32_32x32x16_bf16 v[64:79], v[240:243], v[24:27], v[64:79]
    v_mfma_f32_32x32x16_bf16 v[96:111], v[244:247], v[24:27], v[96:111]
    s_waitcnt vmcnt(8)
    v_mfma_f32_32x32x16_bf16 v[64:79], v[248:251], v[28:31], v[64:79]
    v_mfma_f32_32x32x16_bf16 v[96:111], v[252:255], v[28:31], v[96:111]
    s_waitcnt vmcnt(7)
    v_mfma_f32_32x32x16_bf16 v[80:95], v[192:195], v[32:35], v[80:95]
    v_mfma_f32_32x32x16_bf16 v[112:127], v[196:199], v[32:35], v[112:127]
    s_nop 7
    ds_write_b128 v4, v[64:67] offset:0
    s_waitcnt vmcnt(6)
    v_mfma_f32_32x32x16_bf16 v[80:95], v[200:203], v[36:39], v[80:95]
    v_mfma_f32_32x32x16_bf16 v[112:127], v[204:207], v[36:39], v[112:127]
    ds_write_b128 v5, v[68:71] offset:0
    s_waitcnt vmcnt(5)
    v_mfma_f32_32x32x16_bf16 v[80:95], v[208:211], v[40:43], v[80:95]
    v_mfma_f32_32x32x16_bf16 v[112:127], v[212:215], v[40:43], v[112:127]
    ds_write_b128 v6, v[72:75] offset:0
    s_waitcnt vmcnt(4)
    v_mfma_f32_32x32x16_bf16 v[80:95], v[216:219], v[44:47], v[80:95]
    v_mfma_f32_32x32x16_bf16 v[112:127], v[220:223], v[44:47], v[112:127]
    ds_write_b128 v7, v[76:79] offset:0
    s_waitcnt vmcnt(3)
    v_mfma_f32_32x32x16_bf16 v[80:95], v[224:227], v[48:51], v[80:95]
    v_mfma_f32_32x32x16_bf16 v[112:127], v[228:231], v[48:51], v[112:127]
    ds_write_b128 v4, v[96:99] offset:4096
    s_waitcnt vmcnt(2)
    v_mfma_f32_32x32x16_bf16 v[80:95], v[232:235], v[52:55], v[80:95]
    v_mfma_f32_32x32x16_bf16 v[112:127], v[236:239], v[52:55], v[112:127]
    ds_write_b128 v5, v[100:103] offset:4096
    s_waitcnt vmcnt(1)
    v_mfma_f32_32x32x16_bf16 v[80:95], v[240:243], v[16:19], v[80:95]
    s_waitcnt vmcnt(0)
    v_mfma_f32_32x32x16_bf16 v[80:95], v[248:251], v[20:23], v[80:95]
    ds_write_b128 v6, v[104:107] offset:4096
    v_mfma_f32_32x32x16_bf16 v[112:127], v[244:247], v[16:19], v[112:127]
    v_mfma_f32_32x32x16_bf16 v[112:127], v[252:255], v[20:23], v[112:127]
    ds_write_b128 v7, v[108:111] offset:4096
    s_mov_b64 exec, 1
    ds_add_u32 v8, v9 offset:12
    s_mov_b64 exec, -1
    s_nop 4
    ds_write_b128 v4, v[80:83] offset:8192
    ds_write_b128 v5, v[84:87] offset:8192
    ds_write_b128 v6, v[88:91] offset:8192
    ds_write_b128 v7, v[92:95] offset:8192
    ds_write_b128 v4, v[112:115] offset:12288
    ds_write_b128 v5, v[116:119] offset:12288
    ds_write_b128 v6, v[120:123] offset:12288
    ds_write_b128 v7, v[124:127] offset:12288
    s_mov_b64 exec, 1
    ds_add_u32 v8, v9 offset:16
    s_mov_b64 exec, -1
    s_branch L_rotend
L_rot1:
    s_add_u32 s39, s3, 4096
    buffer_load_dwordx4 v[16:19], v2, s[68:71], s39 offen sc1
    buffer_load_dwordx4 v[20:23], v3, s[68:71], s39 offen sc1
    s_add_u32 s39, s3, 5120
    buffer_load_dwordx4 v[24:27], v2, s[68:71], s39 offen sc1
    buffer_load_dwordx4 v[28:31], v3, s[68:71], s39 offen sc1
    s_add_u32 s39, s3, 6144
    buffer_load_dwordx4 v[32:35], v2, s[68:71], s39 offen sc1
    buffer_load_dwordx4 v[36:39], v3, s[68:71], s39 offen sc1
    s_add_u32 s39, s3, 7168
    buffer_load_dwordx4 v[40:43], v2, s[68:71], s39 offen sc1
    buffer_load_dwordx4 v[44:47], v3, s[68:71], s39 offen sc1
    s_add_u32 s39, s3, 8192
    buffer_load_dwordx4 v[48:51], v2, s[68:71], s39 offen sc1
    buffer_load_dwordx4 v[52:55], v3, s[68:71], s39 offen sc1
    s_waitcnt vmcnt(10)
    ds_read_b128 v[192:195], v6 offset:0
    ds_read_b128 v[196:199], v6 offset:4096
    ds_read_b128 v[200:203], v7 offset:0
    ds_read_b128 v[204:207], v7 offset:4096
    ds_read_b128 v[208:211], v6 offset:8192
    ds_read_b128 v[212:215], v6 offset:12288
    ds_read_b128 v[216:219], v7 offset:8192
    ds_read_b128 v[220:223], v7 offset:12288
    ds_read_b128 v[224:227], v8 offset:0
    ds_read_b128 v[228:231], v8 offset:4096
    ds_read_b128 v[232:235], v9 offset:0
    ds_read_b128 v[236:239], v9 offset:4096
    ds_read_b128 v[240:243], v8 offset:8192
    ds_read_b128 v[244:247], v8 offset:12288
    ds_read_b128 v[248:251], v9 offset:8192
    ds_read_b128 v[252:255], v9 offset:12288
    s_waitcnt lgkmcnt(0)
    v_lshrrev_b32 v5, 5, v1
    v_and_b32 v6, 7, v1
    v_and_b32 v4, 31, v1
    v_xor_b32 v5, v5, v6
    v_lshlrev_b32 v5, 4, v5
    v_lshl_add_u32 v4, v4, 7, v5
    v_add_u32 v4, s35, v4
    v_xor_b32 v5, 32, v4
    v_xor_b32 v6, 64, v4
    v_xor_b32 v7, 0x60, v4
    v_mov_b32 v8, 160768
    v_mov_b32 v9, 1
    s_waitcnt vmcnt(9)
    v_mfma_f32_32x32x16_bf16 v[64:79], v[160:163], v[16:19], 0
    v_mfma_f32_32x32x16_bf16 v[96:111], v[164:167], v[16:19], 0
    s_add_u32 s39, s3, 9216
    buffer_load_dwordx4 v[16:19], v2, s[68:71], s39 offen sc1
    s_waitcnt vmcnt(9)
    v_mfma_f32_32x32x16_bf16 v[80:95], v[160:163], v[20:23], 0
    v_mfma_f32_32x32x16_bf16 v[112:127], v[164:167], v[20:23], 0
    buffer_load_dwordx4 v[20:23], v3, s[68:71], s39 offen sc1
    s_waitcnt vmcnt(9)
    v_mfma_f32_32x32x16_bf16 v[64:79], v[168:171], v[24:27], v[64:79]
    v_mfma_f32_32x32x16_bf16 v[96:111], v[172:175], v[24:27], v[96:111]
    s_add_u32 s39, s3, 10240
    buffer_load_dwordx4 v[24:27], v2, s[68:71], s39 offen sc1
    s_waitcnt vmcnt(9)
    v_mfma_f32_32x32x16_bf16 v[80:95], v[168:171], v[28:31], v[80:95]
    v_mfma_f32_32x32x16_bf16 v[112:127], v[172:175], v[28:31], v[112:127]
    buffer_load_dwordx4 v[28:31], v3, s[68:71], s39 offen sc1
    s_waitcnt vmcnt(9)
    v_mfma_f32_32x32x16_bf16 v[64:79], v[176:179], v[32:35], v[64:79]
    v_mfma_f32_32x32x16_bf16 v[96:111], v[180:183], v[32:35], v[96:111]
    s_add_u32 s39, s3, 11264
    buffer_load_dwordx4 v[32:35], v2, s[68:71], s39 offen sc1
    s_waitcnt vmcnt(9)
    v_mfma_f32_32x32x16_bf16 v[80:95], v[176:179], v[36:39], v[80:95]
    v_mfma_f32_32x32x16_bf16 v[112:127], v[180:183], v[36:39], v[112:127]
    buffer_load_dwordx4 v[36:39], v3, s[68:71], s39 offen sc1
    s_waitcnt vmcnt(9)
    v_mfma_f32_32x32x16_bf16 v[64:79], v[184:187], v[40:43], v[64:79]
    v_mfma_f32_32x32x16_bf16 v[96:111], v[188:191], v[40:43], v[96:111]
    s_add_u32 s39, s3, 12288
    buffer_load_dwordx4 v[40:43], v2, s[68:71], s39 offen sc1
    s_waitcnt vmcnt(9)
    v_mfma_f32_32x32x16_bf16 v[80:95], v[184:187], v[44:47], v[80:95]
    v_mfma_f32_32x32x16_bf16 v[112:127], v[188:191], v[44:47], v[112:127]
    s_add_u32 s39, s3, 13312
    buffer_load_dwordx4 v[44:47], v2, s[68:71], s39 offen sc1
    s_waitcnt vmcnt(9)
    v_mfma_f32_32x32x16_bf16 v[64:79], v[192:195], v[48:51], v[64:79]
    v_mfma_f32_32x32x16_bf16 v[96:111], v[196:199], v[48:51], v[96:111]
    s_add_u32 s39, s3, 14336
    buffer_load_dwordx4 v[48:51], v2, s[68:71], s39 offen sc1
    s_waitcnt vmcnt(9)
    v_mfma_f32_32x32x16_bf16 v[80:95], v[192:195], v[52:55], v[80:95]
    v_mfma_f32_32x32x16_bf16 v[112:127], v[196:199], v[52:55], v[112:127]
    s_add_u32 s39, s3, 15360
    buffer_load_dwordx4 v[52:55], v2, s[68:71], s39 offen sc1
    s_waitcnt vmcnt(9)
    v_mfma_f32_32x32x16_bf16 v[64:79], v[200:203], v[16:19], v[64:79]
    v_mfma_f32_32x32x16_bf16 v[96:111], v[204:207], v[16:19], v[96:111]
    s_bitcmp0_b32 s16, 0
    s_cbranch_scc1 L_nw_14
L_nb_15:
    s_add_u32 s39, s3, 0
    buffer_load_dwordx4 v[16:19], v2, s[68:71], s39 offen sc1
    s_waitcnt vmcnt(9)
    v_mfma_f32_32x32x16_bf16 v[80:95], v[200:203], v[20:23], v[80:95]
    v_mfma_f32_32x32x16_bf16 v[112:127], v[204:207], v[20:23], v[112:127]
    s_add_u32 s39, s3, 1024
    buffer_load_dwordx4 v[20:23], v2, s[68:71], s39 offen sc1
    s_waitcnt vmcnt(9)
    v_mfma_f32_32x32x16_bf16 v[64:79], v[208:211], v[24:27], v[64:79]
    v_mfma_f32_32x32x16_bf16 v[96:111], v[212:215], v[24:27], v[96:111]
    s_add_u32 s39, s3, 2048
    buffer_load_dwordx4 v[24:27], v2, s[68:71], s39 offen sc1
    s_waitcnt vmcnt(9)
    v_mfma_f32_32x32x16_bf16 v[80:95], v[208:211], v[28:31], v[80:95]
    v_mfma_f32_32x32x16_bf16 v[112:127], v[212:215], v[28:31], v[112:127]
    s_add_u32 s39, s3, 3072
    buffer_load_dwordx4 v[28:31], v2, s[68:71], s39 offen sc1
    s_waitcnt vmcnt(9)
    v_mfma_f32_32x32x16_bf16 v[64:79], v[216:219], v[32:35], v[64:79]
    v_mfma_f32_32x32x16_bf16 v[96:111], v[220:223], v[32:35], v[96:111]
    s_add_u32 s39, s3, 12288
    buffer_load_dwordx4 v[32:35], v3, s[68:71], s39 offen sc1
    s_waitcnt vmcnt(9)
    v_mfma_f32_32x32x16_bf16 v[80:95], v[216:219], v[36:39], v[80:95]
    v_mfma_f32_32x32x16_bf16 v[112:127], v[220:223], v[36:39], v[112:127]
    s_add_u32 s39, s3, 13312
    buffer_load_dwordx4 v[36:39], v3, s[68:71], s39 offen sc1
    s_waitcnt vmcnt(9)
    v_mfma_f32_32x32x16_bf16 v[64:79], v[224:227], v[40:43], v[64:79]
    v_mfma_f32_32x32x16_bf16 v[96:111], v[228:231], v[40:43], v[96:111]
    s_add_u32 s39, s3, 14336
    buffer_load_dwordx4 v[40:43], v3, s[68:71], s39 offen sc1
    s_waitcnt vmcnt(9)
    v_mfma_f32_32x32x16_bf16 v[64:79], v[232:235], v[44:47], v[64:79]
    v_mfma_f32_32x32x16_bf16 v[96:111], v[236:239], v[44:47], v[96:111]
    s_add_u32 s39, s3, 15360
    buffer_load_dwordx4 v[44:47], v3, s[68:71], s39 offen sc1
    s_waitcnt vmcnt(9)
    v_mfma_f32_32x32x16_bf16 v[64:79], v[240:243], v[48:51], v[64:79]
    v_mfma_f32_32x32x16_bf16 v[96:111], v[244:247], v[48:51], v[96:111]
    s_add_u32 s39, s3, 0
    buffer_load_dwordx4 v[48:51], v3, s[68:71], s39 offen sc1
    s_waitcnt vmcnt(9)
    v_mfma_f32_32x32x16_bf16 v[64:79], v[248:251], v[52:55], v[64:79]
    v_mfma_f32_32x32x16_bf16 v[96:111], v[252:255], v[52:55], v[96:111]
    s_add_u32 s39, s3, 1024
    buffer_load_dwordx4 v[52:55], v3, s[68:71], s39 offen sc1
    s_waitcnt vmcnt(9)
    v_mfma_f32_32x32x16_bf16 v[64:79], v[128:131], v[16:19], v[64:79]
    v_mfma_f32_32x32x16_bf16 v[96:111], v[132:135], v[16:19], v[96:111]
    s_add_u32 s39, s3, 2048
    buffer_load_dwordx4 v[16:19], v3, s[68:71], s39 offen sc1
    s_waitcnt vmcnt(9)
    v_mfma_f32_32x32x16_bf16 v[64:79], v[136:139], v[20:23], v[64:79]
    v_mfma_f32_32x32x16_bf16 v[96:111], v[140:143], v[20:23], v[96:111]
    s_add_u32 s39, s3, 3072
    buffer_load_dwordx4 v[20:23], v3, s[68:71], s39 offen sc1
    s_waitcnt vmcnt(9)
    v_mfma_f32_32x32x16_bf16 v[64:79], v[144:147], v[24:27], v[64:79]
    v_mfma_f32_32x32x16_bf16 v[96:111], v[148:151], v[24:27], v[96:111]
    s_waitcnt vmcnt(8)
    v_mfma_f32_32x32x16_bf16 v[64:79], v[152:155], v[28:31], v[64:79]
    v_mfma_f32_32x32x16_bf16 v[96:111], v[156:159], v[28:31], v[96:111]
    s_waitcnt vmcnt(7)
    v_mfma_f32_32x32x16_bf16 v[80:95], v[224:227], v[32:35], v[80:95]
    v_mfma_f32_32x32x16_bf16 v[112:127], v[228:231], v[32:35], v[112:127]
    s_nop 7
    ds_write_b128 v4, v[64:67] offset:0
    s_waitcnt vmcnt(6)
    v_mfma_f32_32x32x16_bf16 v[80:95], v[232:235], v[36:39], v[80:95]
    v_mfma_f32_32x32x16_bf16 v[112:127], v[236:239], v[36:39], v[112:127]
    ds_write_b128 v5, v[68:71] offset:0
    s_waitcnt vmcnt(5)
    v_mfma_f32_32x32x16_bf16 v[80:95], v[240:243], v[40:43], v[80:95]
    v_mfma_f32_32x32x16_bf16 v[112:127], v[244:247], v[40:43], v[112:127]
    ds_write_b128 v6, v[72:75] offset:0
    s_waitcnt vmcnt(4)
    v_mfma_f32_32x32x16_bf16 v[80:95], v[248:251], v[44:47], v[80:95]
    v_mfma_f32_32x32x16_bf16 v[112:127], v[252:255], v[44:47], v[112:127]
    ds_write_b128 v7, v[76:79] offset:0
    s_waitcnt vmcnt(3)
    v_mfma_f32_32x32x16_bf16 v[80:95], v[128:131], v[48:51], v[80:95]
    v_mfma_f32_32x32x16_bf16 v[112:127], v[132:135], v[48:51], v[112:127]
    ds_write_b128 v4, v[96:99] offset:4096
    s_waitcnt vmcnt(2)
    v_mfma_f32_32x32x16_bf16 v[80:95], v[136:139], v[52:55], v[80:95]
    v_mfma_f32_32x32x16_bf16 v[112:127], v[140:143], v[52:55], v[112:127]
    ds_write_b128 v5, v[100:103] offset:4096
    s_waitcnt vmcnt(1)
    v_mfma_f32_32x32x16_bf16 v[80:95], v[144:147], v[16:19], v[80:95]
    s_waitcnt vmcnt(0)
    v_mfma_f32_32x32x16_bf16 v[80:95], v[152:155], v[20:23], v[80:95]
    ds_write_b128 v6, v[104:107] offset:4096
    v_mfma_f32_32x32x16_bf16 v[112:127], v[148:151], v[16:19], v[112:127]
    v_mfma_f32_32x32x16_bf16 v[112:127], v[156:159], v[20:23], v[112:127]
    ds_write_b128 v7, v[108:111] offset:4096
    s_mov_b64 exec, 1
    ds_add_u32 v8, v9 offset:12
    s_mov_b64 exec, -1
    s_nop 4
    ds_write_b128 v4, v[80:83] offset:8192
    ds_write_b128 v5, v[84:87] offset:8192
    ds_write_b128 v6, v[88:91] offset:8192
    ds_write_b128 v7, v[92:95] offset:8192
    ds_write_b128 v4, v[112:115] offset:12288
    ds_write_b128 v5, v[116:119] offset:12288
    ds_write_b128 v6, v[120:123] offset:12288
    ds_write_b128 v7, v[124:127] offset:12288
    s_mov_b64 exec, 1
    ds_add_u32 v8, v9 offset:16
    s_mov_b64 exec, -1
    s_branch L_rotend
L_rot2:
    s_add_u32 s39, s3, 8192
    buffer_load_dwordx4 v[16:19], v2, s[68:71], s39 offen sc1
    buffer_load_dwordx4 v[20:23], v3, s[68:71], s39 offen sc1
    s_add_u32 s39, s3, 9216
    buffer_load_dwordx4 v[24:27], v2, s[68:71], s39 offen sc1
    buffer_load_dwordx4 v[28:31], v3, s[68:71], s39 offen sc1
    s_add_u32 s39, s3, 10240
    buffer_load_dwordx4 v[32:35], v2, s[68:71], s39 offen sc1
    buffer_load_dwordx4 v[36:39], v3, s[68:71], s39 offen sc1
    s_add_u32 s39, s3, 11264
    buffer_load_dwordx4 v[40:43], v2, s[68:71], s39 offen sc1
    buffer_load_dwordx4 v[44:47], v3, s[68:71], s39 offen sc1
    s_add_u32 s39, s3, 12288
    buffer_load_dwordx4 v[48:51], v2, s[68:71], s39 offen sc1
    buffer_load_dwordx4 v[52:55], v3, s[68:71], s39 offen sc1
    s_waitcnt vmcnt(10)
    ds_read_b128 v[192:195], v6 offset:0
    ds_read_b128 v[196:199], v6 offset:4096
    ds_read_b128 v[200:203], v7 offset:0
    ds_read_b128 v[204:207], v7 offset:4096
    ds_read_b128 v[208:211], v6 offset:8192
    ds_read_b128 v[212:215], v6 offset:12288
    ds_read_b128 v[216:219], v7 offset:8192
    ds_read_b128 v[220:223], v7 offset:12288
    ds_read_b128 v[224:227], v8 offset:0
    ds_read_b128 v[228:231], v8 offset:4096
    ds_read_b128 v[232:235], v9 offset:0
    ds_read_b128 v[236:239], v9 offset:4096
    ds_read_b128 v[240:243], v8 offset:8192
    ds_read_b128 v[244:247], v8 offset:12288
    ds_read_b128 v[248:251], v9 offset:8192
    ds_read_b128 v[252:255], v9 offset:12288
    s_waitcnt lgkmcnt(0)
    v_lshrrev_b32 v5, 5, v1
    v_and_b32 v6, 7, v1
    v_and_b32 v4, 31, v1
    v_xor_b32 v5, v5, v6
    v_lshlrev_b32 v5, 4, v5
    v_lshl_add_u32 v4, v4, 7, v5
    v_add_u32 v4, s35, v4
    v_xor_b32 v5, 32, v4
    v_xor_b32 v6, 64, v4
    v_xor_b32 v7, 0x60, v4
    v_mov_b32 v8, 160768
    v_mov_b32 v9, 1
    s_waitcnt vmcnt(9)
    v_mfma_f32_32x32x16_bf16 v[64:79], v[192:195], v[16:19], 0
    v_mfma_f32_32x32x16_bf16 v[96:111], v[196:199], v[16:19], 0
    s_add_u32 s39, s3, 13312
    buffer_load_dwordx4 v[16:19], v2, s[68:71], s39 offen sc1
    s_waitcnt vmcnt(9)
    v_mfma_f32_32x32x16_bf16 v[80:95], v[192:195], v[20:23], 0
    v_mfma_f32_32x32x16_bf16 v[112:127], v[196:199], v[20:23], 0
    buffer_load_dwordx4 v[20:23], v3, s[68:71], s39 offen sc1
    s_waitcnt vmcnt(9)
    v_mfma_f32_32x32x16_bf16 v[64:79], v[200:203], v[24:27], v[64:79]
    v_mfma_f32_32x32x16_bf16 v[96:111], v[204:207], v[24:27], v[96:111]
    s_add_u32 s39, s3, 14336
    buffer_load_dwordx4 v[24:27], v2, s[68:71], s39 offen sc1
    s_waitcnt vmcnt(9)
    v_mfma_f32_32x32x16_bf16 v[80:95], v[200:203], v[28:31], v[80:95]
    v_mfma_f32_32x32x16_bf16 v[112:127], v[204:207], v[28:31], v[112:127]
    buffer_load_dwordx4 v[28:31], v3, s[68:71], s39 offen sc1
    s_waitcnt vmcnt(9)
    v_mfma_f32_32x32x16_bf16 v[64:79], v[208:211], v[32:35], v[64:79]
    v_mfma_f32_32x32x16_bf16 v[96:111], v[212:215], v[32:35], v[96:111]
    s_add_u32 s39, s3, 15360
    buffer_load_dwordx4 v[32:35], v2, s[68:71], s39 offen sc1
    s_waitcnt vmcnt(9)
    v_mfma_f32_32x32x16_bf16 v[80:95], v[208:211], v[36:39], v[80:95]
    v_mfma_f32_32x32x16_bf16 v[112:127], v[212:215], v[36:39], v[112:127]
    buffer_load_dwordx4 v[36:39], v3, s[68:71], s39 offen sc1
    s_waitcnt vmcnt(9)
    v_mfma_f32_32x32x16_bf16 v[64:79], v[216:219], v[40:43], v[64:79]
    v_mfma_f32_32x32x16_bf16 v[96:111], v[220:223], v[40:43], v[96:111]
    s_add_u32 s39, s3, 0
    buffer_load_dwordx4 v[40:43], v2, s[68:71], s39 offen sc1
    s_waitcnt vmcnt(9)
    v_mfma_f32_32x32x16_bf16 v[80:95], v[216:219], v[44:47], v[80:95]
    v_mfma_f32_32x32x16_bf16 v[112:127], v[220:223], v[44:47], v[112:127]
    s_add_u32 s39, s3, 1024
    buffer_load_dwordx4 v[44:47], v2, s[68:71], s39 offen sc1
    s_waitcnt vmcnt(9)
    v_mfma_f32_32x32x16_bf16 v[64:79], v[224:227], v[48:51], v[64:79]
    v_mfma_f32_32x32x16_bf16 v[96:111], v[228:231], v[48:51], v[96:111]
    s_add_u32 s39, s3, 2048
    buffer_load_dwordx4 v[48:51], v2, s[68:71], s39 offen sc1
    s_waitcnt vmcnt(9)
    v_mfma_f32_32x32x16_bf16 v[80:95], v[224:227], v[52:55], v[80:95]
    v_mfma_f32_32x32x16_bf16 v[112:127], v[228:231], v[52:55], v[112:127]
    s_add_u32 s39, s3, 3072
    buffer_load_dwordx4 v[52:55], v2, s[68:71], s39 offen sc1
    s_waitcnt vmcnt(9)
    v_mfma_f32_32x32x16_bf16 v[64:79], v[232:235], v[16:19], v[64:79]
    v_mfma_f32_32x32x16_bf16 v[96:111], v[236:239], v[16:19], v[96:111]
    s_bitcmp0_b32 s16, 1
    s_cbranch_scc1 L_nw_16
L_nb_17:
    s_add_u32 s39, s3, 4096
    buffer_load_dwordx4 v[16:19], v2, s[68:71], s39 offen sc1
    s_waitcnt vmcnt(9)
    v_mfma_f32_32x32x16_bf16 v[80:95], v[232:235], v[20:23], v[80:95]
    v_mfma_f32_32x32x16_bf16 v[112:127], v[236:239], v[20:23], v[112:127]
    s_add_u32 s39, s3, 5120
    buffer_load_dwordx4 v[20:23], v2, s[68:71], s39 offen sc1
    s_waitcnt vmcnt(9)
    v_mfma_f32_32x32x16_bf16 v[64:79], v[240:243], v[24:27], v[64:79]
    v_mfma_f32_32x32x16_bf16 v[96:111], v[244:247], v[24:27], v[96:111]
    s_add_u32 s39, s3, 6144
    buffer_load_dwordx4 v[24:27], v2, s[68:71], s39 offen sc1
    s_waitcnt vmcnt(9)
    v_mfma_f32_32x32x16_bf16 v[80:95], v[240:243], v[28:31], v[80:95]
    v_mfma_f32_32x32x16_bf16 v[112:127], v[244:247], v[28:31], v[112:127]
    s_add_u32 s39, s3, 7168
    buffer_load_dwordx4 v[28:31], v2, s[68:71], s39 offen sc1
    s_waitcnt vmcnt(9)
    v_mfma_f32_32x32x16_bf16 v[64:79], v[248:251], v[32:35], v[64:79]
    v_mfma_f32_32x32x16_bf16 v[96:111], v[252:255], v[32:35], v[96:111]
    s_add_u32 s39, s3, 0
    buffer_load_dwordx4 v[32:35], v3, s[68:71], s39 offen sc1
    s_waitcnt vmcnt(9)
    v_mfma_f32_32x32x16_bf16 v[80:95], v[248:251], v[36:39], v[80:95]
    v_mfma_f32_32x32x16_bf16 v[112:127], v[252:255], v[36:39], v[112:127]
    s_add_u32 s39, s3, 1024
    buffer_load_dwordx4 v[36:39], v3, s[68:71], s39 offen sc1
    s_waitcnt vmcnt(9)
    v_mfma_f32_32x32x16_bf16 v[64:79], v[128:131], v[40:43], v[64:79]
    v_mfma_f32_32x32x16_bf16 v[96:111], v[132:135], v[40:43], v[96:111]
    s_add_u32 s39, s3, 2048
    buffer_load_dwordx4 v[40:43], v3, s[68:71], s39 offen sc1
    s_waitcnt vmcnt(9)
    v_mfma_f32_32x32x16_bf16 v[64:79], v[136:139], v[44:47], v[64:79]
    v_mfma_f32_32x32x16_bf16 v[96:111], v[140:143], v[44:47], v[96:111]
    s_add_u32 s39, s3, 3072
    buffer_load_dwordx4 v[44:47], v3, s[68:71], s39 offen sc1
    s_waitcnt vmcnt(9)
    v_mfma_f32_32x32x16_bf16 v[64:79], v[144:147], v[48:51], v[64:79]
    v_mfma_f32_32x32x16_bf16 v[96:111], v[148:151], v[48:51], v[96:111]
    s_add_u32 s39, s3, 4096
    buffer_load_dwordx4 v[48:51], v3, s[68:71], s39 offen sc1
    s_waitcnt vmcnt(9)
    v_mfma_f32_32x32x16_bf16 v[64:79], v[152:155], v[52:55], v[64:79]
    v_mfma_f32_32x32x16_bf16 v[96:111], v[156:159], v[52:55], v[96:111]
    s_add_u32 s39, s3, 5120
    buffer_load_dwordx4 v[52:55], v3, s[68:71], s39 offen sc1
    s_waitcnt vmcnt(9)
    v_mfma_f32_32x32x16_bf16 v[64:79], v[160:163], v[16:19], v[64:79]
    v_mfma_f32_32x32x16_bf16 v[96:111], v[164:167], v[16:19], v[96:111]
    s_add_u32 s39, s3, 6144
    buffer_load_dwordx4 v[16:19], v3, s[68:71], s39 offen sc1
    s_waitcnt vmcnt(9)
    v_mfma_f32_32x32x16_bf16 v[64:79], v[168:171], v[20:23], v[64:79]
    v_mfma_f32_32x32x16_bf16 v[96:111], v[172:175], v[20:23], v[96:111]
    s_add_u32 s39, s3, 7168
    buffer_load_dwordx4 v[20:23], v3, s[68:71], s39 offen sc1
    s_waitcnt vmcnt(9)
    v_mfma_f32_32x32x16_bf16 v[64:79], v[176:179], v[24:27], v[64:79]
    v_mfma_f32_32x32x16_bf16 v[96:111], v[180:183], v[24:27], v[96:111]
    s_waitcnt vmcnt(8)
    v_mfma_f32_32x32x16_bf16 v[64:79], v[184:187], v[28:31], v[64:79]
    v_mfma_f32_32x32x16_bf16 v[96:111], v[188:191], v[28:31], v[96:111]
    s_waitcnt vmcnt(7)
    v_mfma_f32_32x32x16_bf16 v[80:95], v[128:131], v[32:35], v[80:95]
    v_mfma_f32_32x32x16_bf16 v[112:127], v[132:135], v[32:35], v[112:127]
    s_nop 7
    ds_write_b128 v4, v[64:67] offset:0
    s_waitcnt vmcnt(6)
    v_mfma_f32_32x32x16_bf16 v[80:95], v[136:139], v[36:39], v[80:95]
    v_mfma_f32_32x32x16_bf16 v[112:127], v[140:143], v[36:39], v[112:127]
    ds_write_b128 v5, v[68:71] offset:0
    s_waitcnt vmcnt(5)
    v_mfma_f32_32x32x16_bf16 v[80:95], v[144:147], v[40:43], v[80:95]
    v_mfma_f32_32x32x16_bf16 v[112:127], v[148:151], v[40:43], v[112:127]
    ds_write_b128 v6, v[72:75] offset:0
    s_waitcnt vmcnt(4)
    v_mfma_f32_32x32x16_bf16 v[80:95], v[152:155], v[44:47], v[80:95]
    v_mfma_f32_32x32x16_bf16 v[112:127], v[156:159], v[44:47], v[112:127]
    ds_write_b128 v7, v[76:79] offset:0
    s_waitcnt vmcnt(3)
    v_mfma_f32_32x32x16_bf16 v[80:95], v[160:163], v[48:51], v[80:95]
    v_mfma_f32_32x32x16_bf16 v[112:127], v[164:167], v[48:51], v[112:127]
    ds_write_b128 v4, v[96:99] offset:4096
    s_waitcnt vmcnt(2)
    v_mfma_f32_32x32x16_bf16 v[80:95], v[168:171], v[52:55], v[80:95]
    v_mfma_f32_32x32x16_bf16 v[112:127], v[172:175], v[52:55], v[112:127]
    ds_write_b128 v5, v[100:103] offset:4096
    s_waitcnt vmcnt(1)
    v_mfma_f32_32x32x16_bf16 v[80:95], v[176:179], v[16:19], v[80:95]
    s_waitcnt vmcnt(0)
    v_mfma_f32_32x32x16_bf16 v[80:95], v[184:187], v[20:23], v[80:95]
    ds_write_b128 v6, v[104:107] offset:4096
    v_mfma_f32_32x32x16_bf16 v[112:127], v[180:183], v[16:19], v[112:127]
    v_mfma_f32_32x32x16_bf16 v[112:127], v[188:191], v[20:23], v[112:127]
    ds_write_b128 v7, v[108:111] offset:4096
    s_mov_b64 exec, 1
    ds_add_u32 v8, v9 offset:12
    s_mov_b64 exec, -1
    s_nop 4
    ds_write_b128 v4, v[80:83] offset:8192
    ds_write_b128 v5, v[84:87] offset:8192
    ds_write_b128 v6, v[88:91] offset:8192
    ds_write_b128 v7, v[92:95] offset:8192
    ds_write_b128 v4, v[112:115] offset:12288
    ds_write_b128 v5, v[116:119] offset:12288
    ds_write_b128 v6, v[120:123] offset:12288
    ds_write_b128 v7, v[124:127] offset:12288
    s_mov_b64 exec, 1
    ds_add_u32 v8, v9 offset:16
    s_mov_b64 exec, -1
    s_branch L_rotend
L_rot3:
    s_add_u32 s39, s3, 12288
    buffer_load_dwordx4 v[16:19], v2, s[68:71], s39 offen sc1
    buffer_load_dwordx4 v[20:23], v3, s[68:71], s39 offen sc1
    s_add_u32 s39, s3, 13312
    buffer_load_dwordx4 v[24:27], v2, s[68:71], s39 offen sc1
    buffer_load_dwordx4 v[28:31], v3, s[68:71], s39 offen sc1
    s_add_u32 s39, s3, 14336
    buffer_load_dwordx4 v[32:35], v2, s[68:71], s39 offen sc1
    buffer_load_dwordx4 v[36:39], v3, s[68:71], s39 offen sc1
    s_add_u32 s39, s3, 15360
    buffer_load_dwordx4 v[40:43], v2, s[68:71], s39 offen sc1
    buffer_load_dwordx4 v[44:47], v3, s[68:71], s39 offen sc1
    s_add_u32 s39, s3, 0
    buffer_load_dwordx4 v[48:51], v2, s[68:71], s39 offen sc1
    buffer_load_dwordx4 v[52:55], v3, s[68:71], s39 offen sc1
    s_waitcnt vmcnt(10)
    ds_read_b128 v[192:195], v6 offset:0
    ds_read_b128 v[196:199], v6 offset:4096
    ds_read_b128 v[200:203], v7 offset:0
    ds_read_b128 v[204:207], v7 offset:4096
    ds_read_b128 v[208:211], v6 offset:8192
    ds_read_b128 v[212:215], v6 offset:12288
    ds_read_b128 v[216:219], v7 offset:8192
    ds_read_b128 v[220:223], v7 offset:12288
    ds_read_b128 v[224:227], v8 offset:0
    ds_read_b128 v[228:231], v8 offset:4096
    ds_read_b128 v[232:235], v9 offset:0
    ds_read_b128 v[236:239], v9 offset:4096
    ds_read_b128 v[240:243], v8 offset:8192
    ds_read_b128 v[244:247], v8 offset:12288
    ds_read_b128 v[248:251], v9 offset:8192
    ds_read_b128 v[252:255], v9 offset:12288
    s_waitcnt lgkmcnt(0)
    v_lshrrev_b32 v5, 5, v1
    v_and_b32 v6, 7, v1
    v_and_b32 v4, 31, v1
    v_xor_b32 v5, v5, v6
    v_lshlrev_b32 v5, 4, v5
    v_lshl_add_u32 v4, v4, 7, v5
    v_add_u32 v4, s35, v4
    v_xor_b32 v5, 32, v4
    v_xor_b32 v6, 64, v4
    v_xor_b32 v7, 0x60, v4
    v_mov_b32 v8, 160768
    v_mov_b32 v9, 1
    s_waitcnt vmcnt(9)
    v_mfma_f32_32x32x16_bf16 v[64:79], v[224:227], v[16:19], 0
    v_mfma_f32_32x32x16_bf16 v[96:111], v[228:231], v[16:19], 0
    s_add_u32 s39, s3, 1024
    buffer_load_dwordx4 v[16:19], v2, s[68:71], s39 offen sc1
    s_waitcnt vmcnt(9)
    v_mfma_f32_32x32x16_bf16 v[80:95], v[224:227], v[20:23], 0
    v_mfma_f32_32x32x16_bf16 v[112:127], v[228:231], v[20:23], 0
    buffer_load_dwordx4 v[20:23], v3, s[68:71], s39 offen sc1
    s_waitcnt vmcnt(9)
    v_mfma_f32_32x32x16_bf16 v[64:79], v[232:235], v[24:27], v[64:79]
    v_mfma_f32_32x32x16_bf16 v[96:111], v[236:239], v[24:27], v[96:111]
    s_add_u32 s39, s3, 2048
    buffer_load_dwordx4 v[24:27], v2, s[68:71], s39 offen sc1
    s_waitcnt vmcnt(9)
    v_mfma_f32_32x32x16_bf16 v[80:95], v[232:235], v[28:31], v[80:95]
    v_mfma_f32_32x32x16_bf16 v[112:127], v[236:239], v[28:31], v[112:127]
    buffer_load_dwordx4 v[28:31], v3, s[68:71], s39 offen sc1
    s_waitcnt vmcnt(9)
    v_mfma_f32_32x32x16_bf16 v[64:79], v[240:243], v[32:35], v[64:79]
    v_mfma_f32_32x32x16_bf16 v[96:111], v[244:247], v[32:35], v[96:111]
    s_add_u32 s39, s3, 3072
    buffer_load_dwordx4 v[32:35], v2, s[68:71], s39 offen sc1
    s_waitcnt vmcnt(9)
    v_mfma_f32_32x32x16_bf16 v[80:95], v[240:243], v[36:39], v[80:95]
    v_mfma_f32_32x32x16_bf16 v[112:127], v[244:247], v[36:39], v[112:127]
    buffer_load_dwordx4 v[36:39], v3, s[68:71], s39 offen sc1
    s_waitcnt vmcnt(9)
    v_mfma_f32_32x32x16_bf16 v[64:79], v[248:251], v[40:43], v[64:79]
    v_mfma_f32_32x32x16_bf16 v[96:111], v[252:255], v[40:43], v[96:111]
    s_add_u32 s39, s3, 4096
    buffer_load_dwordx4 v[40:43], v2, s[68:71], s39 offen sc1
    s_waitcnt vmcnt(9)
    v_mfma_f32_32x32x16_bf16 v[80:95], v[248:251], v[44:47], v[80:95]
    v_mfma_f32_32x32x16_bf16 v[112:127], v[252:255], v[44:47], v[112:127]
    s_add_u32 s39, s3, 5120
    buffer_load_dwordx4 v[44:47], v2, s[68:71], s39 offen sc1
    s_waitcnt vmcnt(9)
    v_mfma_f32_32x32x16_bf16 v[64:79], v[128:131], v[48:51], v[64:79]
    v_mfma_f32_32x32x16_bf16 v[96:111], v[132:135], v[48:51], v[96:111]
    s_add_u32 s39, s3, 6144
    buffer_load_dwordx4 v[48:51], v2, s[68:71], s39 offen sc1
    s_waitcnt vmcnt(9)
    v_mfma_f32_32x32x16_bf16 v[80:95], v[128:131], v[52:55], v[80:95]
    v_mfma_f32_32x32x16_bf16 v[112:127], v[132:135], v[52:55], v[112:127]
    s_add_u32 s39, s3, 7168
    buffer_load_dwordx4 v[52:55], v2, s[68:71], s39 offen sc1
    s_waitcnt vmcnt(9)
    v_mfma_f32_32x32x16_bf16 v[64:79], v[136:139], v[16:19], v[64:79]
    v_mfma_f32_32x32x16_bf16 v[96:111], v[140:143], v[16:19], v[96:111]
    s_bitcmp0_b32 s16, 2
    s_cbranch_scc1 L_nw_18
L_nb_19:
    s_add_u32 s39, s3, 8192
    buffer_load_dwordx4 v[16:19], v2, s[68:71], s39 offen sc1
    s_waitcnt vmcnt(9)
    v_mfma_f32_32x32x16_bf16 v[80:95], v[136:139], v[20:23], v[80:95]
    v_mfma_f32_32x32x16_bf16 v[112:127], v[140:143], v[20:23], v[112:127]
    s_add_u32 s39, s3, 9216
    buffer_load_dwordx4 v[20:23], v2, s[68:71], s39 offen sc1
    s_waitcnt vmcnt(9)
    v_mfma_f32_32x32x16_bf16 v[64:79], v[144:147], v[24:27], v[64:79]
    v_mfma_f32_32x32x16_bf16 v[96:111], v[148:151], v[24:27], v[96:111]
    s_add_u32 s39, s3, 10240
    buffer_load_dwordx4 v[24:27], v2, s[68:71], s39 offen sc1
    s_waitcnt vmcnt(9)
    v_mfma_f32_32x32x16_bf16 v[80:95], v[144:147], v[28:31], v[80:95]
    v_mfma_f32_32x32x16_bf16 v[112:127], v[148:151], v[28:31], v[112:127]
    s_add_u32 s39, s3, 11264
    buffer_load_dwordx4 v[28:31], v2, s[68:71], s39 offen sc1
    s_waitcnt vmcnt(9)
    v_mfma_f32_32x32x16_bf16 v[64:79], v[152:155], v[32:35], v[64:79]
    v_mfma_f32_32x32x16_bf16 v[96:111], v[156:159], v[32:35], v[96:111]
    s_add_u32 s39, s3, 4096
    buffer_load_dwordx4 v[32:35], v3, s[68:71], s39 offen sc1
    s_waitcnt vmcnt(9)
    v_mfma_f32_32x32x16_bf16 v[80:95], v[152:155], v[36:39], v[80:95]
    v_mfma_f32_32x32x16_bf16 v[112:127], v[156:159], v[36:39], v[112:127]
    s_add_u32 s39, s3, 5120
    buffer_load_dwordx4 v[36:39], v3, s[68:71], s39 offen sc1
    s_waitcnt vmcnt(9)
    v_mfma_f32_32x32x16_bf16 v[64:79], v[160:163], v[40:43], v[64:79]
    v_mfma_f32_32x32x16_bf16 v[96:111], v[164:167], v[40:43], v[96:111]
    s_add_u32 s39, s3, 6144
    buffer_load_dwordx4 v[40:43], v3, s[68:71], s39 offen sc1
    s_waitcnt vmcnt(9)
    v_mfma_f32_32x32x16_bf16 v[64:79], v[168:171], v[44:47], v[64:79]
    v_mfma_f32_32x32x16_bf16 v[96:111], v[172:175], v[44:47], v[96:111]
    s_add_u32 s39, s3, 7168
    buffer_load_dwordx4 v[44:47], v3, s[68:71], s39 offen sc1
    s_waitcnt vmcnt(9)
    v_mfma_f32_32x32x16_bf16 v[64:79], v[176:179], v[48:51], v[64:79]
    v_mfma_f32_32x32x16_bf16 v[96:111], v[180:183], v[48:51], v[96:111]
    s_add_u32 s39, s3, 8192
    buffer_load_dwordx4 v[48:51], v3, s[68:71], s39 offen sc1
    s_waitcnt vmcnt(9)
    v_mfma_f32_32x32x16_bf16 v[64:79], v[184:187], v[52:55], v[64:79]
    v_mfma_f32_32x32x16_bf16 v[96:111], v[188:191], v[52:55], v[96:111]
    s_add_u32 s39, s3, 9216
    buffer_load_dwordx4 v[52:55], v3, s[68:71], s39 offen sc1
    s_waitcnt vmcnt(9)
    v_mfma_f32_32x32x16_bf16 v[64:79], v[192:195], v[16:19], v[64:79]
    v_mfma_f32_32x32x16_bf16 v[96:111], v[196:199], v[16:19], v[96:111]
    s_add_u32 s39, s3, 10240
    buffer_load_dwordx4 v[16:19], v3, s[68:71], s39 offen sc1
    s_waitcnt vmcnt(9)
    v_mfma_f32_32x32x16_bf16 v[64:79], v[200:203], v[20:23], v[64:79]
    v_mfma_f32_32x32x16_bf16 v[96:111], v[204:207], v[20:23], v[96:111]
    s_add_u32 s39, s3, 11264
    buffer_load_dwordx4 v[20:23], v3, s[68:71], s39 offen sc1
    s_waitcnt vmcnt(9)
    v_mfma_f32_32x32x16_bf16 v[64:79], v[208:211], v[24:27], v[64:79]
    v_mfma_f32_32x32x16_bf16 v[96:111], v[212:215], v[24:27], v[96:111]
    s_waitcnt vmcnt(8)
    v_mfma_f32_32x32x16_bf16 v[64:79], v[216:219], v[28:31], v[64:79]
    v_mfma_f32_32x32x16_bf16 v[96:111], v[220:223], v[28:31], v[96:111]
    s_waitcnt vmcnt(7)
    v_mfma_f32_32x32x16_bf16 v[80:95], v[160:163], v[32:35], v[80:95]
    v_mfma_f32_32x32x16_bf16 v[112:127], v[164:167], v[32:35], v[112:127]
    s_nop 7
    ds_write_b128 v4, v[64:67] offset:0
    s_waitcnt vmcnt(6)
    v_mfma_f32_32x32x16_bf16 v[80:95], v[168:171], v[36:39], v[80:95]
    v_mfma_f32_32x32x16_bf16 v[112:127], v[172:175], v[36:39], v[112:127]
    ds_write_b128 v5, v[68:71] offset:0
    s_waitcnt vmcnt(5)
    v_mfma_f32_32x32x16_bf16 v[80:95], v[176:179], v[40:43], v[80:95]
    v_mfma_f32_32x32x16_bf16 v[112:127], v[180:183], v[40:43], v[112:127]
    ds_write_b128 v6, v[72:75] offset:0
    s_waitcnt vmcnt(4)
    v_mfma_f32_32x32x16_bf16 v[80:95], v[184:187], v[44:47], v[80:95]
    v_mfma_f32_32x32x16_bf16 v[112:127], v[188:191], v[44:47], v[112:127]
    ds_write_b128 v7, v[76:79] offset:0
    s_waitcnt vmcnt(3)
    v_mfma_f32_32x32x16_bf16 v[80:95], v[192:195], v[48:51], v[80:95]
    v_mfma_f32_32x32x16_bf16 v[112:127], v[196:199], v[48:51], v[112:127]
    ds_write_b128 v4, v[96:99] offset:4096
    s_waitcnt vmcnt(2)
    v_mfma_f32_32x32x16_bf16 v[80:95], v[200:203], v[52:55], v[80:95]
    v_mfma_f32_32x32x16_bf16 v[112:127], v[204:207], v[52:55], v[112:127]
    ds_write_b128 v5, v[100:103] offset:4096
    s_waitcnt vmcnt(1)
    v_mfma_f32_32x32x16_bf16 v[80:95], v[208:211], v[16:19], v[80:95]
    s_waitcnt vmcnt(0)
    v_mfma_f32_32x32x16_bf16 v[80:95], v[216:219], v[20:23], v[80:95]
    ds_write_b128 v6, v[104:107] offset:4096
    v_mfma_f32_32x32x16_bf16 v[112:127], v[212:215], v[16:19], v[112:127]
    v_mfma_f32_32x32x16_bf16 v[112:127], v[220:223], v[20:23], v[112:127]
    ds_write_b128 v7, v[108:111] offset:4096
    s_mov_b64 exec, 1
    ds_add_u32 v8, v9 offset:12
    s_mov_b64 exec, -1
    s_nop 4
    ds_write_b128 v4, v[80:83] offset:8192
    ds_write_b128 v5, v[84:87] offset:8192
    ds_write_b128 v6, v[88:91] offset:8192
    ds_write_b128 v7, v[92:95] offset:8192
    ds_write_b128 v4, v[112:115] offset:12288
    ds_write_b128 v5, v[116:119] offset:12288
    ds_write_b128 v6, v[120:123] offset:12288
    ds_write_b128 v7, v[124:127] offset:12288
    s_mov_b64 exec, 1
    ds_add_u32 v8, v9 offset:16
    s_mov_b64 exec, -1
L_rotend:
    s_endpgm
L_gr_3:
    s_sleep 8
    buffer_load_dwordx2 v[250:251], v58, s[68:71], s17 offen sc1
    s_waitcnt vmcnt(0)
    s_sub_u32 s83, s83, 1
    s_cmp_lg_u32 s83, 0
    s_cbranch_scc1 L_gc_2
    s_branch L_gx_4
L_lbr_8:
    s_sleep 4
    buffer_load_dwordx4 v[80:83], v18, s[68:71], s28 offen sc1
    buffer_load_dwordx4 v[84:87], v19, s[68:71], s28 offen sc1
    s_waitcnt vmcnt(0)
    s_sub_u32 s83, s83, 1
    s_cmp_lg_u32 s83, 0
    s_cbranch_scc1 L_lb_6
    s_branch L_lbd_7
L_rotsel:
    s_bitcmp1_b32 s18, 1
    s_cbranch_scc1 L_rot1
    s_bitcmp1_b32 s18, 2
    s_cbranch_scc1 L_rot2
    s_branch L_rot3
L_nw_12:
    s_mov_b32 s83, 131072
L_nt_20:
    s_load_dwordx2 s[8:9], s[20:21], 384 glc
    s_waitcnt lgkmcnt(0)
    s_cmp_eq_u64 s[8:9], s[78:79]
    s_cbranch_scc1 L_nb_13
    s_sleep 4
    s_sub_u32 s83, s83, 1
    s_cmp_lg_u32 s83, 0
    s_cbranch_scc1 L_nt_20
    s_branch L_nb_13
L_nw_14:
    s_mov_b32 s83, 131072
L_nt_21:
    s_load_dwordx2 s[8:9], s[20:21], 0 glc
    s_waitcnt lgkmcnt(0)
    s_cmp_eq_u64 s[8:9], s[78:79]
    s_cbranch_scc1 L_nb_15
    s_sleep 4
    s_sub_u32 s83, s83, 1
    s_cmp_lg_u32 s83, 0
    s_cbranch_scc1 L_nt_21
    s_branch L_nb_15
L_nw_16:
    s_mov_b32 s83, 131072
L_nt_22:
    s_load_dwordx2 s[8:9], s[20:21], 128 glc
    s_waitcnt lgkmcnt(0)
    s_cmp_eq_u64 s[8:9], s[78:79]
    s_cbranch_scc1 L_nb_17
    s_sleep 4
    s_sub_u32 s83, s83, 1
    s_cmp_lg_u32 s83, 0
    s_cbranch_scc1 L_nt_22
    s_branch L_nb_17
L_nw_18:
    s_mov_b32 s83, 131072
L_nt_23:
    s_load_dwordx2 s[8:9], s[20:21], 256 glc
    s_waitcnt lgkmcnt(0)
    s_cmp_eq_u64 s[8:9], s[78:79]
    s_cbranch_scc1 L_nb_19
    s_sleep 4
    s_sub_u32 s83, s83, 1
    s_cmp_lg_u32 s83, 0
    s_cbranch_scc1 L_nt_23
    s_branch L_nb_19
.p2align 6
L_F:
    v_bfe_u32 v23, v1, 2, 2
    v_lshl_add_u32 v23, v20, 3, v23
    v_lshlrev_b32 v23, 6, v23
    v_bfe_u32 v24, v1, 4, 1
    v_lshl_add_u32 v23, v24, 5, v23
    v_and_b32 v24, 1, v1
    v_lshl_add_u32 v23, v24, 4, v23
    v_bfe_u32 v24, v1, 1, 1
    v_lshl_add_u32 v23, v24, 3, v23
    v_add_u32 v6, 49152, v23
    s_waitcnt lgkmcnt(0)
    s_load_dword s78, s[36:37], 0
    s_mov_b32 s40, s8
    s_mov_b32 s41, s9
    s_mov_b32 s42, 0x200000
    s_mov_b32 s43, 0x20000
    s_cmp_ge_u32 s73, 2
    s_cselect_b32 s44, s16, s14
    s_cselect_b32 s45, s17, s15
    s_mov_b32 s46, 0x80000
    s_mov_b32 s47, 0x20000
    s_lshl_b32 s3, s74, 4
    s_add_u32 s3, s3, s75
    s_lshl_b32 s80, s3, 2
    s_add_u32 s80, s80, s73
    s_lshl_b32 s80, s80, 11
    s_lshl_b32 s6, s75, 4
    s_add_u32 s6, s6, s74
    s_lshl_b32 s82, s6, 1
    s_and_b32 s81, s73, 1
    s_add_u32 s82, s82, s81
    s_lshl_b32 s82, s82, 10
    s_mov_b32 s7, s80
    s_mov_b32 s39, s82
    buffer_load_dwordx4 v[144:147], v31, s[40:43], s7 offen
    buffer_load_dwordx4 v[148:151], v31, s[40:43], s7 offen offset:1024
    buffer_load_dwordx4 v[152:155], v31, s[44:47], s39 offen
    s_lshl_b32 s80, s75, 6
    s_lshl_b32 s81, s77, 7
    s_cmp_eq_u32 s73, 1
    s_cselect_b32 s10, s12, s10
    s_cselect_b32 s11, s13, s11
    s_cmp_eq_u32 s73, 2
    s_cselect_b32 s10, s22, s10
    s_cselect_b32 s11, s23, s11
    s_cmp_eq_u32 s73, 3
    s_cselect_b32 s10, s24, s10
    s_cselect_b32 s11, s25, s11
    s_cselect_b32 s80, s81, s80
    s_cselect_b32 s81, -1, 0xffff
    v_lshl_add_u32 v23, v1, 2, s80
    s_mov_b32 exec_lo, s81
    s_mov_b32 exec_hi, 0
    global_load_dword v228, v23, s[10:11]
    s_mov_b64 exec, -1
    s_mov_b32 s68, s36
    s_mov_b32 s69, s37
    s_mov_b32 s70, 0xe80000
    s_mov_b32 s71, 0x20000
    s_mov_b32 s38, 0xffff0000
    v_and_b32 v21, 31, v1
    v_bfe_u32 v22, v1, 1, 3
    v_xor_b32 v23, v20, v22
    v_lshlrev_b32 v23, 4, v23
    v_lshl_add_u32 v23, v21, 7, v23
    s_lshl_b32 s80, s73, 12
    v_add_u32 v2, s80, v23
    v_xor_b32 v3, 32, v2
    v_xor_b32 v4, 64, v2
    v_xor_b32 v5, 0x60, v2
    s_mov_b32 s52, s30
    s_mov_b32 s53, s31
    s_mov_b32 s54, 0x158000
    s_mov_b32 s55, 0x20000
    s_mov_b32 s64, s32
    s_mov_b32 s65, s33
    s_mov_b32 s66, 0x400000
    s_mov_b32 s67, 0x20000
    v_lshrrev_b32 v242, 4, v0
    v_and_b32 v243, 15, v0
    v_bfe_u32 v234, v242, 2, 1
    v_lshrrev_b32 v235, 3, v242
    v_and_b32 v244, 3, v242
    v_lshl_add_u32 v244, v234, 4, v244
    v_lshl_add_u32 v244, v235, 2, v244
    v_bfe_u32 v24, v1, 2, 1
    v_bfe_u32 v25, v1, 3, 2
    v_and_b32 v26, 3, v1
    v_lshl_add_u32 v26, v24, 4, v26
    v_lshl_add_u32 v26, v25, 2, v26
    v_lshrrev_b32 v24, 3, v26
    v_and_b32 v30, 7, v26
    v_lshlrev_b32 v30, 3, v30
    v_lshl_add_u32 v30, v24, 7, v30
    s_lshl_b32 s4, s74, 11
    s_lshl_b32 s80, s73, 9
    s_add_u32 s4, s4, s80
    s_add_u32 s4, s4, 32768
    v_mov_b32 v129, 0
    v_mov_b32 v130, 0
    v_mov_b32 v131, 0
    v_mov_b32 v133, 0
    v_mov_b32 v134, 0
    v_mov_b32 v135, 0
    v_mov_b32 v137, 0
    v_mov_b32 v138, 0
    v_mov_b32 v139, 0
    v_mov_b32 v141, 0
    v_mov_b32 v142, 0
    v_mov_b32 v143, 0
    v_mov_b32 v8, 160768
    v_mov_b32 v9, 1
    v_mov_b32 v140, 0
    ds_write_b128 v8, v[140:143]
    ds_write_b128 v8, v[140:143] offset:16
    ds_write_b128 v8, v[140:143] offset:32
    v_mov_b32 v156, 0x3f803f80
    v_mov_b32 v157, 0x3f803f80
    v_mov_b32 v158, 0x3f803f80
    v_mov_b32 v159, 0x3f803f80
    s_mov_b32 s12, 0xffffff00
    s_mov_b32 s13, 0xffffff00
    s_lshl_b32 s80, s74, 2
    s_lshr_b64 s[12:13], s[12:13], s80
    s_and_b32 s18, s12, 15
    s_cmp_eq_u32 s73, 0
    s_cselect_b32 s18, s18, 15
    s_lshl_b32 s80, s75, 11
    s_add_u32 s17, s80, 229376
    s_lshl_b32 s80, s74, 1
    s_lshr_b32 s81, 0xd0008, s80
    s_and_b32 s81, s81, 3
    s_lshl_b32 s81, s81, 9
    s_add_u32 s14, s17, s81
    s_lshl_b32 s80, s3, 7
    s_lshl_b32 s81, s73, 4
    s_add_u32 s80, s80, s81
    s_add_u32 s80, s80, 32768
    s_add_u32 s28, s36, s80
    s_addc_u32 s29, s37, 0
    s_lshl_b32 s80, s6, 4
    s_add_u32 s80, s80, s73
    s_lshl_b32 s80, s80, 3
    s_add_u32 s80, s80, 196608
    s_add_u32 s22, s36, s80
    s_addc_u32 s23, s37, 0
    v_lshrrev_b32 v248, 3, v1
    v_and_b32 v23, 7, v1
    v_bfe_u32 v24, v1, 4, 1
    v_lshlrev_b32 v24, 2, v24
    v_xor_b32 v23, v23, v24
    v_lshlrev_b32 v23, 4, v23
    v_lshl_add_u32 v248, v248, 10, v23
    v_add_u32 v253, 0x1c00, v248
    v_bfe_u32 v23, v1, 2, 2
    v_lshl_add_u32 v249, v20, 3, v23
    v_lshlrev_b32 v249, 7, v249
    v_bfe_u32 v23, v1, 3, 1
    v_lshl_add_u32 v249, v23, 6, v249
    v_bfe_u32 v23, v1, 4, 1
    v_lshl_add_u32 v249, v23, 5, v249
    v_and_b32 v23, 3, v1
    v_lshl_add_u32 v249, v23, 3, v249
    s_lshl_b32 s34, s73, 11
    s_add_u32 s34, s34, 151552
    s_mul_i32 s35, s73, 20480
    v_add_u32 v251, s35, v249
    v_add_u32 v249, s34, v249
    v_xor_b32 v250, 64, v249
    v_xor_b32 v252, 64, v251
    s_and_b32 s15, s76, 1
    s_lshl_b32 s15, s15, 2
    s_add_u32 s15, s15, s73
    s_mul_i32 s100, s15, 11264
    s_lshl_b32 s5, s100, 4
    s_lshl_b32 s80, s77, 7
    s_add_u32 s5, s5, s80
    s_lshl_b32 s80, s74, 2
    s_add_u32 s80, s80, s73
    s_mul_i32 s80, s80, 155648
    s_lshl_b32 s81, s98, 11
    s_add_u32 s80, s80, s81
    s_add_u32 s0, s80, 5242880
    s_add_u32 s1, s0, 4096
    s_sub_u32 s80, s101, 11
    s_cmp_lt_u32 s80, 4
    s_cselect_b32 s80, 0x7ff00000, 0
    v_add_u32 v7, s80, v31
    s_lshl_b32 s80, s15, 1
    s_max_u32 s80, s80, 1
    s_sub_u32 s80, s80, 1
    s_lshr_b32 s81, s76, 1
    s_lshl_b32 s81, s81, 4
    s_add_u32 s80, s80, s81
    s_lshl_b32 s80, s80, 7
    s_add_u32 s80, s80, 786432
    s_add_u32 s20, s36, s80
    s_addc_u32 s21, s37, 0
    s_lshl_b32 s80, s74, 4
    s_add_u32 s80, s80, s101
    s_lshl_b32 s80, s80, 7
    s_lshl_b32 s81, s73, 2
    s_add_u32 s80, s80, s81
    s_add_u32 s80, s80, 786432
    s_add_u32 s26, s36, s80
    s_addc_u32 s27, s37, 0
    s_waitcnt lgkmcnt(0)
    s_add_u32 s78, s78, 0x9e3779b9
    s_mov_b32 s79, s78
    s_lshl_b32 s80, s2, 7
    s_add_u32 s80, s80, 983040
    s_sub_u32 s81, s26, s36
    s_cmp_eq_u32 s73, 1
    s_cselect_b32 s80, s81, s80
    s_add_u32 s81, s81, 32768
    s_cmp_eq_u32 s73, 2
    s_cselect_b32 s80, s81, s80
    s_sub_u32 s81, s28, s36
    s_cmp_eq_u32 s73, 3
    s_cselect_b32 s80, s81, s80
    s_load_dword s16, s[36:37], s80 glc
    s_load_dword s19, s[22:23], 0x0 glc
    s_lshl_b32 s80, s3, 2
    s_add_u32 s80, s80, s73
    s_lshl_b32 s80, s80, 7
    s_add_u32 s80, s80, 65596
    s_load_dwordx2 s[30:31], s[36:37], s80 glc
    s_waitcnt vmcnt(1)
    v_lshlrev_b32 v216, 16, v144
    v_and_b32 v217, s38, v144
    v_lshlrev_b32 v218, 16, v145
    v_and_b32 v219, s38, v145
    v_lshlrev_b32 v220, 16, v146
    v_and_b32 v221, s38, v146
    v_lshlrev_b32 v222, 16, v147
    v_and_b32 v223, s38, v147
    v_lshlrev_b32 v230, 16, v148
    v_and_b32 v231, s38, v148
    v_lshlrev_b32 v232, 16, v149
    v_and_b32 v233, s38, v149
    v_lshlrev_b32 v234, 16, v150
    v_and_b32 v235, s38, v150
    v_lshlrev_b32 v236, 16, v151
    v_and_b32 v237, s38, v151
    v_lshlrev_b32 v12, 16, v152
    v_and_b32 v13, s38, v152
    v_lshlrev_b32 v14, 16, v153
    v_and_b32 v15, s38, v153
    v_lshlrev_b32 v16, 16, v154
    v_and_b32 v17, s38, v154
    v_lshlrev_b32 v18, 16, v155
    v_and_b32 v19, s38, v155
    v_add_f32 v224, v216, v217
    v_add_f32 v225, v218, v219
    v_add_f32 v226, v220, v221
    v_add_f32 v227, v222, v223
    v_add_f32 v224, v224, v225
    v_add_f32 v226, v226, v227
    v_add_f32 v224, v224, v226
    v_add_f32 v238, v230, v231
    v_add_f32 v239, v232, v233
    v_add_f32 v240, v234, v235
    v_add_f32 v241, v236, v237
    v_add_f32 v238, v238, v239
    v_add_f32 v240, v240, v241
    v_add_f32 v238, v238, v240
    v_add_f32 v22, v12, v13
    v_add_f32 v23, v14, v15
    v_add_f32 v24, v16, v17
    v_add_f32 v25, v18, v19
    v_add_f32 v22, v22, v23
    v_add_f32 v24, v24, v25
    v_add_f32 v22, v22, v24
    v_add_f32_dpp v224, v224, v224 row_shr:1 row_mask:0xf bank_mask:0xf bound_ctrl:0
    v_add_f32_dpp v238, v238, v238 row_shr:1 row_mask:0xf bank_mask:0xf bound_ctrl:0
    v_add_f32_dpp v22, v22, v22 row_shr:1 row_mask:0xf bank_mask:0xf bound_ctrl:0
    v_add_f32_dpp v224, v224, v224 row_shr:2 row_mask:0xf bank_mask:0xf bound_ctrl:0
    v_add_f32_dpp v238, v238, v238 row_shr:2 row_mask:0xf bank_mask:0xf bound_ctrl:0
    v_add_f32_dpp v22, v22, v22 row_shr:2 row_mask:0xf bank_mask:0xf bound_ctrl:0
    v_add_f32_dpp v224, v224, v224 row_shr:4 row_mask:0xf bank_mask:0xf bound_ctrl:0
    v_add_f32_dpp v238, v238, v238 row_shr:4 row_mask:0xf bank_mask:0xf bound_ctrl:0
    v_add_f32_dpp v22, v22, v22 row_shr:4 row_mask:0xf bank_mask:0xf bound_ctrl:0
    v_add_f32_dpp v224, v224, v224 row_shr:8 row_mask:0xf bank_mask:0xf bound_ctrl:0
    v_add_f32_dpp v238, v238, v238 row_shr:8 row_mask:0xf bank_mask:0xf bound_ctrl:0
    v_add_f32_dpp v22, v22, v22 row_shr:8 row_mask:0xf bank_mask:0xf bound_ctrl:0
    v_add_f32_dpp v224, v224, v224 row_bcast:15 row_mask:0xa bank_mask:0xf
    v_add_f32_dpp v238, v238, v238 row_bcast:15 row_mask:0xa bank_mask:0xf
    v_add_f32_dpp v22, v22, v22 row_bcast:15 row_mask:0xa bank_mask:0xf
    v_add_f32_dpp v224, v224, v224 row_bcast:31 row_mask:0xc bank_mask:0xf
    v_add_f32_dpp v238, v238, v238 row_bcast:31 row_mask:0xc bank_mask:0xf
    v_add_f32_dpp v22, v22, v22 row_bcast:31 row_mask:0xc bank_mask:0xf
    v_readlane_b32 s80, v224, 63
    v_readlane_b32 s81, v238, 63
    v_mov_b32 v225, 0x3b000000
    v_mov_b32 v239, 0x3b000000
    v_mul_f32 v225, s80, v225
    v_mul_f32 v239, s81, v239
    v_sub_f32 v216, v216, v225
    v_sub_f32 v217, v217, v225
    v_sub_f32 v218, v218, v225
    v_sub_f32 v219, v219, v225
    v_sub_f32 v220, v220, v225
    v_sub_f32 v221, v221, v225
    v_sub_f32 v222, v222, v225
    v_sub_f32 v223, v223, v225
    v_mul_f32 v224, v216, v216
    v_mul_f32 v226, v217, v217
    v_fmac_f32 v224, v218, v218
    v_fmac_f32 v226, v219, v219
    v_fmac_f32 v224, v220, v220
    v_fmac_f32 v226, v221, v221
    v_fmac_f32 v224, v222, v222
    v_fmac_f32 v226, v223, v223
    v_add_f32 v224, v224, v226
    v_sub_f32 v230, v230, v239
    v_sub_f32 v231, v231, v239
    v_sub_f32 v232, v232, v239
    v_sub_f32 v233, v233, v239
    v_sub_f32 v234, v234, v239
    v_sub_f32 v235, v235, v239
    v_sub_f32 v236, v236, v239
    v_sub_f32 v237, v237, v239
    v_mul_f32 v238, v230, v230
    v_mul_f32 v240, v231, v231
    v_fmac_f32 v238, v232, v232
    v_fmac_f32 v240, v233, v233
    v_fmac_f32 v238, v234, v234
    v_fmac_f32 v240, v235, v235
    v_fmac_f32 v238, v236, v236
    v_fmac_f32 v240, v237, v237
    v_add_f32 v238, v238, v240
    v_add_f32_dpp v224, v224, v224 row_shr:1 row_mask:0xf bank_mask:0xf bound_ctrl:0
    s_nop 0
    v_add_f32_dpp v238, v238, v238 row_shr:1 row_mask:0xf bank_mask:0xf bound_ctrl:0
    v_add_f32_dpp v224, v224, v224 row_shr:2 row_mask:0xf bank_mask:0xf bound_ctrl:0
    s_nop 0
    v_add_f32_dpp v238, v238, v238 row_shr:2 row_mask:0xf bank_mask:0xf bound_ctrl:0
    v_add_f32_dpp v224, v224, v224 row_shr:4 row_mask:0xf bank_mask:0xf bound_ctrl:0
    s_nop 0
    v_add_f32_dpp v238, v238, v238 row_shr:4 row_mask:0xf bank_mask:0xf bound_ctrl:0
    v_add_f32_dpp v224, v224, v224 row_shr:8 row_mask:0xf bank_mask:0xf bound_ctrl:0
    s_nop 0
    v_add_f32_dpp v238, v238, v238 row_shr:8 row_mask:0xf bank_mask:0xf bound_ctrl:0
    v_add_f32_dpp v224, v224, v224 row_bcast:15 row_mask:0xa bank_mask:0xf
    s_nop 0
    v_add_f32_dpp v238, v238, v238 row_bcast:15 row_mask:0xa bank_mask:0xf
    v_add_f32_dpp v224, v224, v224 row_bcast:31 row_mask:0xc bank_mask:0xf
    s_nop 0
    v_add_f32_dpp v238, v238, v238 row_bcast:31 row_mask:0xc bank_mask:0xf
    v_mul_f32 v224, 0x3b000000, v224
    v_mul_f32 v238, 0x3b000000, v238
    v_cvt_pk_bf16_f32 v224, v224, v224
    v_cvt_pk_bf16_f32 v238, v238, v238
    v_lshlrev_b32 v224, 16, v224
    v_lshlrev_b32 v238, 16, v238
    v_add_f32 v224, 0x3727c5ac, v224
    v_add_f32 v238, 0x3727c5ac, v238
    v_cvt_pk_bf16_f32 v224, v224, v224
    v_cvt_pk_bf16_f32 v238, v238, v238
    v_lshlrev_b32 v224, 16, v224
    v_lshlrev_b32 v238, 16, v238
    v_sqrt_f32 v224, v224
    v_sqrt_f32 v238, v238
    v_cvt_pk_bf16_f32 v224, v224, v225
    v_cvt_pk_bf16_f32 v238, v238, v239
    v_readlane_b32 s12, v22, 63
    v_readlane_b32 s8, v224, 63
    v_readlane_b32 s10, v238, 63
    s_mov_b32 s9, s78
    s_mov_b32 s11, s78
    s_mov_b32 s13, s78
    s_atomic_swap_x2 s[8:9], s[28:29], 0x0
    s_atomic_swap_x2 s[10:11], s[28:29], 0x8
    s_atomic_swap_x2 s[12:13], s[22:23], 0x0
    s_barrier
    ds_read_b128 v[32:35], v2 offset:0
    ds_read_b64_tr_b16 v[36:37], v6 offset:0
    ds_read_b64_tr_b16 v[38:39], v6 offset:256
    ds_read_b64_tr_b16 v[40:41], v6 offset:1024
    ds_read_b64_tr_b16 v[42:43], v6 offset:1280
    ds_read_b64_tr_b16 v[44:45], v6 offset:2048
    ds_read_b64_tr_b16 v[46:47], v6 offset:2304
    ds_read_b128 v[48:51], v3 offset:0
    ds_read_b64_tr_b16 v[52:53], v6 offset:3072
    ds_read_b64_tr_b16 v[54:55], v6 offset:3328
    ds_read_b64_tr_b16 v[56:57], v6 offset:4096
    ds_read_b64_tr_b16 v[58:59], v6 offset:4352
    ds_read_b64_tr_b16 v[60:61], v6 offset:5120
    ds_read_b64_tr_b16 v[62:63], v6 offset:5376
    s_waitcnt lgkmcnt(7)
    v_mfma_f32_32x32x16_bf16 v[80:95], v[36:39], v[32:35], 0
    ds_read_b128 v[64:67], v4 offset:0
    ds_read_b64_tr_b16 v[68:69], v6 offset:6144
    ds_read_b64_tr_b16 v[70:71], v6 offset:6400
    s_lshl_b32 s80, s73, 7
    s_add_u32 s80, s80, 162880
    v_lshl_add_u32 v229, v1, 2, s80
    v_mfma_f32_32x32x16_bf16 v[96:111], v[40:43], v[32:35], 0
    ds_read_b64_tr_b16 v[72:73], v6 offset:7168
    ds_read_b64_tr_b16 v[74:75], v6 offset:7424
    s_waitcnt vmcnt(0)
    s_mov_b32 exec_hi, 0
    ds_write_b32 v229, v228
    s_mov_b64 exec, -1
    v_mfma_f32_32x32x16_bf16 v[112:127], v[44:47], v[32:35], 0
    ds_read_b64_tr_b16 v[76:77], v6 offset:8192
    ds_read_b64_tr_b16 v[78:79], v6 offset:8448
    s_cmp_lg_u32 s18, 0
    s_cbranch_scc1 L_db_25
L_du_24:
    v_mfma_f32_32x32x16_bf16 v[160:175], v[156:159], v[36:39], 0
    v_mfma_f32_32x32x16_bf16 v[176:191], v[156:159], v[40:43], 0
    v_mfma_f32_32x32x16_bf16 v[192:207], v[156:159], v[44:47], 0
L_db_25:
    s_waitcnt lgkmcnt(8)
    v_mfma_f32_32x32x16_bf16 v[80:95], v[52:55], v[48:51], v[80:95]
    ds_read_b128 v[32:35], v5 offset:0
    ds_read_b64_tr_b16 v[36:37], v6 offset:9216
    ds_read_b64_tr_b16 v[38:39], v6 offset:9472
    ds_read_b64_tr_b16 v[40:41], v6 offset:10240
    ds_read_b64_tr_b16 v[42:43], v6 offset:10496
    ds_read_b64_tr_b16 v[44:45], v6 offset:11264
    ds_read_b64_tr_b16 v[46:47], v6 offset:11520
    v_mfma_f32_32x32x16_bf16 v[96:111], v[56:59], v[48:51], v[96:111]
    v_mfma_f32_32x32x16_bf16 v[112:127], v[60:63], v[48:51], v[112:127]
    s_cmp_lg_u32 s18, 0
    s_cbranch_scc1 L_db_27
L_du_26:
    v_mfma_f32_32x32x16_bf16 v[160:175], v[156:159], v[52:55], v[160:175]
    v_mfma_f32_32x32x16_bf16 v[176:191], v[156:159], v[56:59], v[176:191]
    v_mfma_f32_32x32x16_bf16 v[192:207], v[156:159], v[60:63], v[192:207]
L_db_27:
    s_waitcnt lgkmcnt(0)
    s_barrier
    v_mfma_f32_32x32x16_bf16 v[80:95], v[68:71], v[64:67], v[80:95]
    ds_read_b128 v[48:51], v2 offset:16384
    ds_read_b64_tr_b16 v[52:53], v6 offset:12288
    ds_read_b64_tr_b16 v[54:55], v6 offset:12544
    v_lshlrev_b32 v151, 4, v21
    v_add_u32 v151, 160832, v151
    s_lshl_b32 s80, s73, 9
    v_mfma_f32_32x32x16_bf16 v[96:111], v[72:75], v[64:67], v[96:111]
    ds_read_b64_tr_b16 v[56:57], v6 offset:13312
    ds_read_b64_tr_b16 v[58:59], v6 offset:13568
    v_add_u32 v150, s80, v151
    v_mov_b32 v29, s78
    s_lshl_b32 s80, s73, 7
    v_mfma_f32_32x32x16_bf16 v[112:127], v[76:79], v[64:67], v[112:127]
    ds_read_b64_tr_b16 v[60:61], v6 offset:14336
    ds_read_b64_tr_b16 v[62:63], v6 offset:14592
    s_add_u32 s80, s80, 159744
    v_lshl_add_u32 v153, v26, 2, s80
    s_add_u32 s80, s80, 512
    s_cmp_lg_u32 s18, 0
    s_cbranch_scc1 L_db_29
L_du_28:
    v_mfma_f32_32x32x16_bf16 v[160:175], v[156:159], v[68:71], v[160:175]
    v_mfma_f32_32x32x16_bf16 v[176:191], v[156:159], v[72:75], v[176:191]
    v_mfma_f32_32x32x16_bf16 v[192:207], v[156:159], v[76:79], v[192:207]
L_db_29:
    v_mfma_f32_32x32x16_bf16 v[80:95], v[36:39], v[32:35], v[80:95]
    ds_read_b128 v[64:67], v3 offset:16384
    ds_read_b64_tr_b16 v[68:69], v6 offset:15360
    ds_read_b64_tr_b16 v[70:71], v6 offset:15616
    v_lshl_add_u32 v152, v21, 2, s80
    v_mfma_f32_32x32x16_bf16 v[96:111], v[40:43], v[32:35], v[96:111]
    ds_read_b64_tr_b16 v[72:73], v6 offset:16384
    ds_read_b64_tr_b16 v[74:75], v6 offset:16640
    v_mfma_f32_32x32x16_bf16 v[112:127], v[44:47], v[32:35], v[112:127]
    ds_read_b64_tr_b16 v[76:77], v6 offset:17408
    ds_read_b64_tr_b16 v[78:79], v6 offset:17664
    s_cmp_lg_u32 s18, 0
    s_cbranch_scc1 L_db_31
L_du_30:
    v_mfma_f32_32x32x16_bf16 v[160:175], v[156:159], v[36:39], v[160:175]
    v_mfma_f32_32x32x16_bf16 v[176:191], v[156:159], v[40:43], v[176:191]
    v_mfma_f32_32x32x16_bf16 v[192:207], v[156:159], v[44:47], v[192:207]
L_db_31:
    s_waitcnt lgkmcnt(7)
    v_mfma_f32_32x32x16_bf16 v[80:95], v[52:55], v[48:51], v[80:95]
    ds_read_b128 v[32:35], v4 offset:16384
    ds_read_b64_tr_b16 v[36:37], v6 offset:18432
    ds_read_b64_tr_b16 v[38:39], v6 offset:18688
    v_mfma_f32_32x32x16_bf16 v[96:111], v[56:59], v[48:51], v[96:111]
    ds_read_b64_tr_b16 v[40:41], v6 offset:19456
    ds_read_b64_tr_b16 v[42:43], v6 offset:19712
    v_mfma_f32_32x32x16_bf16 v[112:127], v[60:63], v[48:51], v[112:127]
    ds_read_b64_tr_b16 v[44:45], v6 offset:20480
    ds_read_b64_tr_b16 v[46:47], v6 offset:20736
    s_cmp_lg_u32 s18, 0
    s_cbranch_scc1 L_db_33
L_du_32:
    v_mfma_f32_32x32x16_bf16 v[160:175], v[156:159], v[52:55], v[160:175]
    v_mfma_f32_32x32x16_bf16 v[176:191], v[156:159], v[56:59], v[176:191]
    v_mfma_f32_32x32x16_bf16 v[192:207], v[156:159], v[60:63], v[192:207]
L_db_33:
    s_waitcnt lgkmcnt(7)
    v_mfma_f32_32x32x16_bf16 v[80:95], v[68:71], v[64:67], v[80:95]
    ds_read_b128 v[48:51], v5 offset:16384
    ds_read_b64_tr_b16 v[52:53], v6 offset:21504
    ds_read_b64_tr_b16 v[54:55], v6 offset:21760
    ds_read_b64_tr_b16 v[56:57], v6 offset:22528
    ds_read_b64_tr_b16 v[58:59], v6 offset:22784
    ds_read_b64_tr_b16 v[60:61], v6 offset:23552
    ds_read_b64_tr_b16 v[62:63], v6 offset:23808
    v_mfma_f32_32x32x16_bf16 v[96:111], v[72:75], v[64:67], v[96:111]
    v_mfma_f32_32x32x16_bf16 v[112:127], v[76:79], v[64:67], v[112:127]
    s_cmp_lg_u32 s18, 0
    s_cbranch_scc1 L_db_35
L_du_34:
    v_mfma_f32_32x32x16_bf16 v[160:175], v[156:159], v[68:71], v[160:175]
    v_mfma_f32_32x32x16_bf16 v[176:191], v[156:159], v[72:75], v[176:191]
    v_mfma_f32_32x32x16_bf16 v[192:207], v[156:159], v[76:79], v[192:207]
L_db_35:
    s_waitcnt lgkmcnt(0)
    s_barrier
    v_mfma_f32_32x32x16_bf16 v[80:95], v[36:39], v[32:35], v[80:95]
    ds_read_b128 v[64:67], v2 offset:32768
    ds_read_b64_tr_b16 v[68:69], v6 offset:24576
    ds_read_b64_tr_b16 v[70:71], v6 offset:24832
    v_mfma_f32_32x32x16_bf16 v[96:111], v[40:43], v[32:35], v[96:111]
    ds_read_b64_tr_b16 v[72:73], v6 offset:25600
    ds_read_b64_tr_b16 v[74:75], v6 offset:25856
    v_mfma_f32_32x32x16_bf16 v[112:127], v[44:47], v[32:35], v[112:127]
    ds_read_b64_tr_b16 v[76:77], v6 offset:26624
    ds_read_b64_tr_b16 v[78:79], v6 offset:26880
    s_cmp_lg_u32 s18, 0
    s_cbranch_scc1 L_db_37
L_du_36:
    v_mfma_f32_32x32x16_bf16 v[160:175], v[156:159], v[36:39], v[160:175]
    v_mfma_f32_32x32x16_bf16 v[176:191], v[156:159], v[40:43], v[176:191]
    v_mfma_f32_32x32x16_bf16 v[192:207], v[156:159], v[44:47], v[192:207]
L_db_37:
    v_mfma_f32_32x32x16_bf16 v[80:95], v[52:55], v[48:51], v[80:95]
    ds_read_b128 v[32:35], v3 offset:32768
    ds_read_b64_tr_b16 v[36:37], v6 offset:27648
    ds_read_b64_tr_b16 v[38:39], v6 offset:27904
    v_mfma_f32_32x32x16_bf16 v[96:111], v[56:59], v[48:51], v[96:111]
    ds_read_b64_tr_b16 v[40:41], v6 offset:28672
    ds_read_b64_tr_b16 v[42:43], v6 offset:28928
    v_mfma_f32_32x32x16_bf16 v[112:127], v[60:63], v[48:51], v[112:127]
    ds_read_b64_tr_b16 v[44:45], v6 offset:29696
    ds_read_b64_tr_b16 v[46:47], v6 offset:29952
    s_cmp_lg_u32 s18, 0
    s_cbranch_scc1 L_db_39
L_du_38:
    v_mfma_f32_32x32x16_bf16 v[160:175], v[156:159], v[52:55], v[160:175]
    v_mfma_f32_32x32x16_bf16 v[176:191], v[156:159], v[56:59], v[176:191]
    v_mfma_f32_32x32x16_bf16 v[192:207], v[156:159], v[60:63], v[192:207]
    s_nop 9
    v_mov_b32 v208, v160
    v_mov_b32 v209, v176
    v_mov_b32 v210, v192
    v_mov_b32 v211, s78
    s_mov_b32 exec_hi, 0
    buffer_store_dwordx4 v[208:211], v31, s[68:71], s14 offen sc1
    s_mov_b64 exec, -1
L_db_39:
    s_waitcnt lgkmcnt(7)
    v_mfma_f32_32x32x16_bf16 v[80:95], v[68:71], v[64:67], v[80:95]
    ds_read_b128 v[48:51], v4 offset:32768
    ds_read_b64_tr_b16 v[52:53], v6 offset:30720
    ds_read_b64_tr_b16 v[54:55], v6 offset:30976
    v_mfma_f32_32x32x16_bf16 v[96:111], v[72:75], v[64:67], v[96:111]
    ds_read_b64_tr_b16 v[56:57], v6 offset:31744
    ds_read_b64_tr_b16 v[58:59], v6 offset:32000
    v_mfma_f32_32x32x16_bf16 v[112:127], v[76:79], v[64:67], v[112:127]
    ds_read_b64_tr_b16 v[60:61], v6 offset:32768
    ds_read_b64_tr_b16 v[62:63], v6 offset:33024
    s_waitcnt lgkmcnt(7)
    v_mfma_f32_32x32x16_bf16 v[80:95], v[36:39], v[32:35], v[80:95]
    ds_read_b128 v[64:67], v5 offset:32768
    ds_read_b64_tr_b16 v[68:69], v6 offset:33792
    ds_read_b64_tr_b16 v[70:71], v6 offset:34048
    ds_read_b64_tr_b16 v[72:73], v6 offset:34816
    ds_read_b64_tr_b16 v[74:75], v6 offset:35072
    ds_read_b64_tr_b16 v[76:77], v6 offset:35840
    ds_read_b64_tr_b16 v[78:79], v6 offset:36096
    v_mfma_f32_32x32x16_bf16 v[96:111], v[40:43], v[32:35], v[96:111]
    v_mfma_f32_32x32x16_bf16 v[112:127], v[44:47], v[32:35], v[112:127]
    s_waitcnt lgkmcnt(0)
    s_barrier
    v_mfma_f32_32x32x16_bf16 v[80:95], v[52:55], v[48:51], v[80:95]
    ds_read_b128 v[32:35], v2 offset:0
    ds_read_b64_tr_b16 v[36:37], v6 offset:0
    ds_read_b64_tr_b16 v[38:39], v6 offset:256
    v_mfma_f32_32x32x16_bf16 v[96:111], v[56:59], v[48:51], v[96:111]
    ds_read_b64_tr_b16 v[40:41], v6 offset:1024
    ds_read_b64_tr_b16 v[42:43], v6 offset:1280
    v_mfma_f32_32x32x16_bf16 v[112:127], v[60:63], v[48:51], v[112:127]
    ds_read_b64_tr_b16 v[44:45], v6 offset:2048
    ds_read_b64_tr_b16 v[46:47], v6 offset:2304
    v_mfma_f32_32x32x16_bf16 v[80:95], v[68:71], v[64:67], v[80:95]
    ds_read_b128 v[48:51], v3 offset:0
    ds_read_b64_tr_b16 v[52:53], v6 offset:3072
    ds_read_b64_tr_b16 v[54:55], v6 offset:3328
    v_mfma_f32_32x32x16_bf16 v[96:111], v[72:75], v[64:67], v[96:111]
    ds_read_b64_tr_b16 v[56:57], v6 offset:4096
    ds_read_b64_tr_b16 v[58:59], v6 offset:4352
    v_mfma_f32_32x32x16_bf16 v[112:127], v[76:79], v[64:67], v[112:127]
    ds_read_b64_tr_b16 v[60:61], v6 offset:5120
    ds_read_b64_tr_b16 v[62:63], v6 offset:5376
    s_waitcnt lgkmcnt(7)
    v_mfma_f32_32x32x16_bf16 v[80:95], v[36:39], v[32:35], v[80:95]
    ds_read_b128 v[64:67], v4 offset:0
    ds_read_b64_tr_b16 v[68:69], v6 offset:6144
    ds_read_b64_tr_b16 v[70:71], v6 offset:6400
    v_mfma_f32_32x32x16_bf16 v[96:111], v[40:43], v[32:35], v[96:111]
    ds_read_b64_tr_b16 v[72:73], v6 offset:7168
    ds_read_b64_tr_b16 v[74:75], v6 offset:7424
    v_mfma_f32_32x32x16_bf16 v[112:127], v[44:47], v[32:35], v[112:127]
    ds_read_b64_tr_b16 v[76:77], v6 offset:8192
    ds_read_b64_tr_b16 v[78:79], v6 offset:8448
    s_waitcnt lgkmcnt(7)
    v_mfma_f32_32x32x16_bf16 v[80:95], v[52:55], v[48:51], v[80:95]
    ds_read_b128 v[32:35], v5 offset:0
    ds_read_b64_tr_b16 v[36:37], v6 offset:9216
    ds_read_b64_tr_b16 v[38:39], v6 offset:9472
    ds_read_b64_tr_b16 v[40:41], v6 offset:10240
    ds_read_b64_tr_b16 v[42:43], v6 offset:10496
    ds_read_b64_tr_b16 v[44:45], v6 offset:11264
    ds_read_b64_tr_b16 v[46:47], v6 offset:11520
    v_mfma_f32_32x32x16_bf16 v[96:111], v[56:59], v[48:51], v[96:111]
    v_mfma_f32_32x32x16_bf16 v[112:127], v[60:63], v[48:51], v[112:127]
    s_waitcnt lgkmcnt(0)
    s_barrier
    v_mfma_f32_32x32x16_bf16 v[80:95], v[68:71], v[64:67], v[80:95]
    ds_read_b128 v[48:51], v2 offset:16384
    ds_read_b64_tr_b16 v[52:53], v6 offset:12288
    ds_read_b64_tr_b16 v[54:55], v6 offset:12544
    v_mfma_f32_32x32x16_bf16 v[96:111], v[72:75], v[64:67], v[96:111]
    ds_read_b64_tr_b16 v[56:57], v6 offset:13312
    ds_read_b64_tr_b16 v[58:59], v6 offset:13568
    v_mfma_f32_32x32x16_bf16 v[112:127], v[76:79], v[64:67], v[112:127]
    ds_read_b64_tr_b16 v[60:61], v6 offset:14336
    ds_read_b64_tr_b16 v[62:63], v6 offset:14592
    v_mfma_f32_32x32x16_bf16 v[80:95], v[36:39], v[32:35], v[80:95]
    ds_read_b128 v[64:67], v3 offset:16384
    ds_read_b64_tr_b16 v[68:69], v6 offset:15360
    ds_read_b64_tr_b16 v[70:71], v6 offset:15616
    v_mfma_f32_32x32x16_bf16 v[96:111], v[40:43], v[32:35], v[96:111]
    ds_read_b64_tr_b16 v[72:73], v6 offset:16384
    ds_read_b64_tr_b16 v[74:75], v6 offset:16640
    v_mfma_f32_32x32x16_bf16 v[112:127], v[44:47], v[32:35], v[112:127]
    ds_read_b64_tr_b16 v[76:77], v6 offset:17408
    ds_read_b64_tr_b16 v[78:79], v6 offset:17664
    s_waitcnt lgkmcnt(7)
    v_mfma_f32_32x32x16_bf16 v[80:95], v[52:55], v[48:51], v[80:95]
    ds_read_b128 v[32:35], v4 offset:16384
    ds_read_b64_tr_b16 v[36:37], v6 offset:18432
    ds_read_b64_tr_b16 v[38:39], v6 offset:18688
    v_mfma_f32_32x32x16_bf16 v[96:111], v[56:59], v[48:51], v[96:111]
    ds_read_b64_tr_b16 v[40:41], v6 offset:19456
    ds_read_b64_tr_b16 v[42:43], v6 offset:19712
    v_mfma_f32_32x32x16_bf16 v[112:127], v[60:63], v[48:51], v[112:127]
    ds_read_b64_tr_b16 v[44:45], v6 offset:20480
    ds_read_b64_tr_b16 v[46:47], v6 offset:20736
    s_waitcnt lgkmcnt(7)
    v_mfma_f32_32x32x16_bf16 v[80:95], v[68:71], v[64:67], v[80:95]
    ds_read_b128 v[48:51], v5 offset:16384
    ds_read_b64_tr_b16 v[52:53], v6 offset:21504
    ds_read_b64_tr_b16 v[54:55], v6 offset:21760
    ds_read_b64_tr_b16 v[56:57], v6 offset:22528
    ds_read_b64_tr_b16 v[58:59], v6 offset:22784
    ds_read_b64_tr_b16 v[60:61], v6 offset:23552
    ds_read_b64_tr_b16 v[62:63], v6 offset:23808
    v_mfma_f32_32x32x16_bf16 v[96:111], v[72:75], v[64:67], v[96:111]
    v_mfma_f32_32x32x16_bf16 v[112:127], v[76:79], v[64:67], v[112:127]
    s_waitcnt lgkmcnt(0)
    s_barrier
    v_mfma_f32_32x32x16_bf16 v[80:95], v[36:39], v[32:35], v[80:95]
    ds_read_b128 v[64:67], v2 offset:32768
    ds_read_b64_tr_b16 v[68:69], v6 offset:24576
    ds_read_b64_tr_b16 v[70:71], v6 offset:24832
    s_mov_b32 exec_hi, 0
    buffer_load_dwordx2 v[28:29], v30, s[68:71], s4 offen sc1
    s_mov_b64 exec, -1
    v_mfma_f32_32x32x16_bf16 v[96:111], v[40:43], v[32:35], v[96:111]
    ds_read_b64_tr_b16 v[72:73], v6 offset:25600
    ds_read_b64_tr_b16 v[74:75], v6 offset:25856
    buffer_load_dwordx4 v[208:211], v31, s[68:71], s17 offen sc1
    buffer_load_dwordx4 v[212:215], v31, s[68:71], s17 offen offset:1024 sc1
    v_mfma_f32_32x32x16_bf16 v[112:127], v[44:47], v[32:35], v[112:127]
    ds_read_b64_tr_b16 v[76:77], v6 offset:26624
    ds_read_b64_tr_b16 v[78:79], v6 offset:26880
    v_mfma_f32_32x32x16_bf16 v[80:95], v[52:55], v[48:51], v[80:95]
    ds_read_b128 v[32:35], v3 offset:32768
    ds_read_b64_tr_b16 v[36:37], v6 offset:27648
    ds_read_b64_tr_b16 v[38:39], v6 offset:27904
    v_mfma_f32_32x32x16_bf16 v[96:111], v[56:59], v[48:51], v[96:111]
    ds_read_b64_tr_b16 v[40:41], v6 offset:28672
    ds_read_b64_tr_b16 v[42:43], v6 offset:28928
    v_mfma_f32_32x32x16_bf16 v[112:127], v[60:63], v[48:51], v[112:127]
    ds_read_b64_tr_b16 v[44:45], v6 offset:29696
    ds_read_b64_tr_b16 v[46:47], v6 offset:29952
    s_waitcnt lgkmcnt(7)
    v_mfma_f32_32x32x16_bf16 v[80:95], v[68:71], v[64:67], v[80:95]
    ds_read_b128 v[48:51], v4 offset:32768
    ds_read_b64_tr_b16 v[52:53], v6 offset:30720
    ds_read_b64_tr_b16 v[54:55], v6 offset:30976
    v_mfma_f32_32x32x16_bf16 v[96:111], v[72:75], v[64:67], v[96:111]
    ds_read_b64_tr_b16 v[56:57], v6 offset:31744
    ds_read_b64_tr_b16 v[58:59], v6 offset:32000
    v_mfma_f32_32x32x16_bf16 v[112:127], v[76:79], v[64:67], v[112:127]
    ds_read_b64_tr_b16 v[60:61], v6 offset:32768
    ds_read_b64_tr_b16 v[62:63], v6 offset:33024
    s_waitcnt lgkmcnt(7)
    v_mfma_f32_32x32x16_bf16 v[80:95], v[36:39], v[32:35], v[80:95]
    ds_read_b128 v[64:67], v5 offset:32768
    ds_read_b64_tr_b16 v[68:69], v6 offset:33792
    ds_read_b64_tr_b16 v[70:71], v6 offset:34048
    ds_read_b64_tr_b16 v[72:73], v6 offset:34816
    ds_read_b64_tr_b16 v[74:75], v6 offset:35072
    ds_read_b64_tr_b16 v[76:77], v6 offset:35840
    ds_read_b64_tr_b16 v[78:79], v6 offset:36096
    v_mfma_f32_32x32x16_bf16 v[96:111], v[40:43], v[32:35], v[96:111]
    v_mfma_f32_32x32x16_bf16 v[112:127], v[44:47], v[32:35], v[112:127]
    s_waitcnt lgkmcnt(0)
    s_barrier
    v_mfma_f32_32x32x16_bf16 v[80:95], v[52:55], v[48:51], v[80:95]
    ds_read_b128 v[32:35], v2 offset:0
    ds_read_b64_tr_b16 v[36:37], v6 offset:0
    ds_read_b64_tr_b16 v[38:39], v6 offset:256
    v_mfma_f32_32x32x16_bf16 v[96:111], v[56:59], v[48:51], v[96:111]
    ds_read_b64_tr_b16 v[40:41], v6 offset:1024
    ds_read_b64_tr_b16 v[42:43], v6 offset:1280
    v_mfma_f32_32x32x16_bf16 v[112:127], v[60:63], v[48:51], v[112:127]
    ds_read_b64_tr_b16 v[44:45], v6 offset:2048
    ds_read_b64_tr_b16 v[46:47], v6 offset:2304
    v_mfma_f32_32x32x16_bf16 v[80:95], v[68:71], v[64:67], v[80:95]
    ds_read_b128 v[48:51], v3 offset:0
    ds_read_b64_tr_b16 v[52:53], v6 offset:3072
    ds_read_b64_tr_b16 v[54:55], v6 offset:3328
    s_mov_b32 s83, 131072
    s_waitcnt vmcnt(0)
L_gc_40:
    v_xor_b32 v144, s78, v29
    v_xor_b32 v145, s78, v211
    v_xor_b32 v146, s78, v215
    v_or3_b32 v144, v144, v145, v146
    v_cmp_ne_u32 vcc, 0, v144
    s_nop 0
    s_cmp_lg_u64 vcc, 0
    s_cbranch_scc1 L_gr_41
L_gx_42:
    v_mfma_f32_32x32x16_bf16 v[96:111], v[72:75], v[64:67], v[96:111]
    ds_read_b64_tr_b16 v[56:57], v6 offset:4096
    ds_read_b64_tr_b16 v[58:59], v6 offset:4352
    v_mov_b32 v29, v28
    v_add_f32 v160, v208, v212
    v_add_f32 v161, v209, v213
    v_mfma_f32_32x32x16_bf16 v[112:127], v[76:79], v[64:67], v[112:127]
    ds_read_b64_tr_b16 v[60:61], v6 offset:5120
    ds_read_b64_tr_b16 v[62:63], v6 offset:5376
    v_add_f32 v162, v210, v214
    v_mov_b32 v164, v160
    v_mov_b32 v165, v161
    s_waitcnt lgkmcnt(7)
    v_mfma_f32_32x32x16_bf16 v[80:95], v[36:39], v[32:35], v[80:95]
    ds_read_b128 v[64:67], v4 offset:0
    ds_read_b64_tr_b16 v[68:69], v6 offset:6144
    ds_read_b64_tr_b16 v[70:71], v6 offset:6400
    v_mov_b32 v166, v162
    v_and_b32 v140, s38, v28
    v_cmp_gt_u32 vcc, 32, v1
    v_mfma_f32_32x32x16_bf16 v[96:111], v[40:43], v[32:35], v[96:111]
    ds_read_b64_tr_b16 v[72:73], v6 offset:7168
    ds_read_b64_tr_b16 v[74:75], v6 offset:7424
    v_cvt_pk_bf16_f32 v140, -v140, -v140
    v_cndmask_b32 v140, 0, v140, vcc
    v_permlane32_swap_b32 v28, v29
    v_mfma_f32_32x32x16_bf16 v[112:127], v[44:47], v[32:35], v[112:127]
    ds_read_b64_tr_b16 v[76:77], v6 offset:8192
    ds_read_b64_tr_b16 v[78:79], v6 offset:8448
    v_permlane32_swap_b32 v160, v164
    v_permlane32_swap_b32 v161, v165
    v_permlane32_swap_b32 v162, v166
    s_waitcnt lgkmcnt(7)
    v_mfma_f32_32x32x16_bf16 v[80:95], v[52:55], v[48:51], v[80:95]
    ds_read_b128 v[32:35], v5 offset:0
    ds_read_b64_tr_b16 v[36:37], v6 offset:9216
    ds_read_b64_tr_b16 v[38:39], v6 offset:9472
    ds_read_b64_tr_b16 v[40:41], v6 offset:10240
    ds_read_b64_tr_b16 v[42:43], v6 offset:10496
    ds_read_b64_tr_b16 v[44:45], v6 offset:11264
    ds_read_b64_tr_b16 v[46:47], v6 offset:11520
    v_lshlrev_b32 v16, 16, v28
    v_rcp_f32 v14, v16
    v_add_f32 v160, v160, v164
    v_mfma_f32_32x32x16_bf16 v[96:111], v[56:59], v[48:51], v[96:111]
    v_add_f32 v161, v161, v165
    v_add_f32 v162, v162, v166
    ds_write_b32 v152, v28
    v_mfma_f32_32x32x16_bf16 v[112:127], v[60:63], v[48:51], v[112:127]
    ds_write_b32 v153, v14
    v_mul_f32 v14, 0xbfb8aa3b, v14
    v_and_b32 v164, s38, v160
    s_waitcnt lgkmcnt(2)
    s_barrier
    v_mfma_f32_32x32x16_bf16 v[80:95], v[68:71], v[64:67], v[80:95]
    ds_read_b128 v[48:51], v2 offset:16384
    ds_read_b64_tr_b16 v[52:53], v6 offset:12288
    ds_read_b64_tr_b16 v[54:55], v6 offset:12544
    v_sub_f32 v160, v160, v164
    v_cvt_pk_bf16_f32 v128, v160, v164
    v_and_b32 v165, s38, v161
    v_mfma_f32_32x32x16_bf16 v[96:111], v[72:75], v[64:67], v[96:111]
    ds_read_b64_tr_b16 v[56:57], v6 offset:13312
    ds_read_b64_tr_b16 v[58:59], v6 offset:13568
    v_sub_f32 v161, v161, v165
    v_cvt_pk_bf16_f32 v132, v161, v165
    v_and_b32 v166, s38, v162
    v_mfma_f32_32x32x16_bf16 v[112:127], v[76:79], v[64:67], v[112:127]
    ds_read_b64_tr_b16 v[60:61], v6 offset:14336
    ds_read_b64_tr_b16 v[62:63], v6 offset:14592
    v_sub_f32 v162, v162, v166
    v_cvt_pk_bf16_f32 v136, v162, v166
    v_mfma_f32_32x32x16_bf16 v[80:95], v[36:39], v[32:35], v[80:95]
    ds_read_b128 v[64:67], v3 offset:16384
    ds_read_b64_tr_b16 v[68:69], v6 offset:15360
    ds_read_b64_tr_b16 v[70:71], v6 offset:15616
    v_mfma_f32_32x32x16_bf16 v[96:111], v[40:43], v[32:35], v[96:111]
    ds_read_b64_tr_b16 v[72:73], v6 offset:16384
    ds_read_b64_tr_b16 v[74:75], v6 offset:16640
    v_mfma_f32_32x32x16_bf16 v[112:127], v[44:47], v[32:35], v[112:127]
    ds_read_b64_tr_b16 v[76:77], v6 offset:17408
    ds_read_b64_tr_b16 v[78:79], v6 offset:17664
    s_waitcnt lgkmcnt(7)
    v_mfma_f32_32x32x16_bf16 v[80:95], v[52:55], v[48:51], v[80:95]
    ds_read_b128 v[32:35], v4 offset:16384
    ds_read_b64_tr_b16 v[36:37], v6 offset:18432
    ds_read_b64_tr_b16 v[38:39], v6 offset:18688
    v_mfma_f32_32x32x16_bf16 v[96:111], v[56:59], v[48:51], v[96:111]
    ds_read_b64_tr_b16 v[40:41], v6 offset:19456
    ds_read_b64_tr_b16 v[42:43], v6 offset:19712
    v_mfma_f32_32x32x16_bf16 v[112:127], v[60:63], v[48:51], v[112:127]
    ds_read_b64_tr_b16 v[44:45], v6 offset:20480
    ds_read_b64_tr_b16 v[46:47], v6 offset:20736
    s_waitcnt lgkmcnt(7)
    v_mfma_f32_32x32x16_bf16 v[80:95], v[68:71], v[64:67], v[80:95]
    ds_read_b128 v[48:51], v5 offset:16384
    ds_read_b64_tr_b16 v[52:53], v6 offset:21504
    ds_read_b64_tr_b16 v[54:55], v6 offset:21760
    ds_read_b64_tr_b16 v[56:57], v6 offset:22528
    ds_read_b64_tr_b16 v[58:59], v6 offset:22784
    ds_read_b64_tr_b16 v[60:61], v6 offset:23552
    ds_read_b64_tr_b16 v[62:63], v6 offset:23808
    v_mfma_f32_32x32x16_bf16 v[96:111], v[72:75], v[64:67], v[96:111]
    v_mfma_f32_32x32x16_bf16 v[112:127], v[76:79], v[64:67], v[112:127]
    s_waitcnt lgkmcnt(0)
    s_barrier
    v_mfma_f32_32x32x16_bf16 v[80:95], v[36:39], v[32:35], v[80:95]
    v_mfma_f32_32x32x16_bf16 v[80:95], v[52:55], v[48:51], v[80:95]
    v_mfma_f32_32x32x16_bf16 v[80:95], v[128:131], v[140:143], v[80:95]
    s_mov_b32 m0, s34
    s_add_u32 s82, s5, 0
    buffer_load_dwordx4 v248, s[52:55], s82 offen offset:0 lds
    buffer_load_dwordx4 v253, s[52:55], s82 offen offset:1024 lds
    s_add_u32 m0, s35, 0
    s_add_u32 s82, s5, 16384
    buffer_load_dwordx4 v248, s[52:55], s82 offen offset:0 lds
    buffer_load_dwordx4 v253, s[52:55], s82 offen offset:1024 lds
    s_nop 3
    v_mul_f32 v160, v14, v80
    v_mul_f32 v161, v14, v81
    v_mul_f32 v162, v14, v82
    v_mul_f32 v163, v14, v83
    v_mul_f32 v164, v14, v84
    v_mul_f32 v165, v14, v85
    v_mul_f32 v166, v14, v86
    v_mul_f32 v167, v14, v87
    v_exp_f32 v160, v160
    v_mfma_f32_32x32x16_bf16 v[96:111], v[40:43], v[32:35], v[96:111]
    v_exp_f32 v161, v161
    v_exp_f32 v162, v162
    v_exp_f32 v163, v163
    v_exp_f32 v164, v164
    v_mfma_f32_32x32x16_bf16 v[96:111], v[56:59], v[48:51], v[96:111]
    v_exp_f32 v165, v165
    v_exp_f32 v166, v166
    v_exp_f32 v167, v167
    v_fma_f32 v160, v160, v16, v16
    v_fma_f32 v161, v161, v16, v16
    v_fma_f32 v162, v162, v16, v16
    v_fma_f32 v163, v163, v16, v16
    v_fma_f32 v164, v164, v16, v16
    v_fma_f32 v165, v165, v16, v16
    v_fma_f32 v166, v166, v16, v16
    v_fma_f32 v167, v167, v16, v16
    v_rcp_f32 v160, v160
    v_mfma_f32_32x32x16_bf16 v[96:111], v[132:135], v[140:143], v[96:111]
    v_rcp_f32 v161, v161
    v_rcp_f32 v162, v162
    v_rcp_f32 v163, v163
    v_rcp_f32 v164, v164
    v_mfma_f32_32x32x16_bf16 v[112:127], v[44:47], v[32:35], v[112:127]
    v_rcp_f32 v165, v165
    v_rcp_f32 v166, v166
    v_rcp_f32 v167, v167
    v_mul_f32 v160, v160, v80
    v_mul_f32 v161, v161, v81
    v_mul_f32 v162, v162, v82
    v_mul_f32 v163, v163, v83
    v_mul_f32 v164, v164, v84
    v_mul_f32 v165, v165, v85
    v_mul_f32 v166, v166, v86
    v_mul_f32 v167, v167, v87
    v_cvt_pk_bf16_f32 v176, v160, v161
    v_cvt_pk_bf16_f32 v177, v162, v163
    v_cvt_pk_bf16_f32 v178, v164, v165
    v_cvt_pk_bf16_f32 v179, v166, v167
    buffer_store_dwordx4 v[176:179], v31, s[68:71], s0 offen offset:0 sc1
    s_add_u32 m0, s35, 2048
    s_add_u32 s82, s5, 32768
    buffer_load_dwordx4 v248, s[52:55], s82 offen offset:0 lds
    v_mul_f32 v168, v14, v88
    v_mul_f32 v169, v14, v89
    v_mul_f32 v170, v14, v90
    v_mul_f32 v171, v14, v91
    v_mul_f32 v172, v14, v92
    v_mul_f32 v173, v14, v93
    v_mul_f32 v174, v14, v94
    v_mul_f32 v175, v14, v95
    v_exp_f32 v168, v168
    v_mfma_f32_32x32x16_bf16 v[112:127], v[60:63], v[48:51], v[112:127]
    v_exp_f32 v169, v169
    v_exp_f32 v170, v170
    v_exp_f32 v171, v171
    v_exp_f32 v172, v172
    v_mfma_f32_32x32x16_bf16 v[112:127], v[136:139], v[140:143], v[112:127]
    v_exp_f32 v173, v173
    v_exp_f32 v174, v174
    v_exp_f32 v175, v175
    v_fma_f32 v168, v168, v16, v16
    v_fma_f32 v169, v169, v16, v16
    v_fma_f32 v170, v170, v16, v16
    v_fma_f32 v171, v171, v16, v16
    v_fma_f32 v172, v172, v16, v16
    v_fma_f32 v173, v173, v16, v16
    v_fma_f32 v174, v174, v16, v16
    v_fma_f32 v175, v175, v16, v16
    v_rcp_f32 v168, v168
    v_rcp_f32 v169, v169
    v_rcp_f32 v170, v170
    v_rcp_f32 v171, v171
    v_rcp_f32 v172, v172
    v_rcp_f32 v173, v173
    v_rcp_f32 v174, v174
    v_rcp_f32 v175, v175
    v_mul_f32 v168, v168, v88
    v_mul_f32 v169, v169, v89
    v_mul_f32 v170, v170, v90
    v_mul_f32 v171, v171, v91
    v_mul_f32 v172, v172, v92
    v_mul_f32 v173, v173, v93
    v_mul_f32 v174, v174, v94
    v_mul_f32 v175, v175, v95
    v_cvt_pk_bf16_f32 v180, v168, v169
    v_cvt_pk_bf16_f32 v181, v170, v171
    v_cvt_pk_bf16_f32 v182, v172, v173
    v_cvt_pk_bf16_f32 v183, v174, v175
    buffer_store_dwordx4 v[180:183], v31, s[68:71], s0 offen offset:1024 sc1
    buffer_load_dwordx4 v253, s[52:55], s82 offen offset:1024 lds
    v_mul_f32 v160, v14, v96
    v_mul_f32 v161, v14, v97
    v_mul_f32 v162, v14, v98
    v_mul_f32 v163, v14, v99
    v_mul_f32 v164, v14, v100
    v_mul_f32 v165, v14, v101
    v_mul_f32 v166, v14, v102
    v_mul_f32 v167, v14, v103
    v_exp_f32 v160, v160
    v_exp_f32 v161, v161
    v_exp_f32 v162, v162
    v_exp_f32 v163, v163
    v_exp_f32 v164, v164
    v_exp_f32 v165, v165
    v_exp_f32 v166, v166
    v_exp_f32 v167, v167
    v_fma_f32 v160, v160, v16, v16
    v_fma_f32 v161, v161, v16, v16
    v_fma_f32 v162, v162, v16, v16
    v_fma_f32 v163, v163, v16, v16
    v_fma_f32 v164, v164, v16, v16
    v_fma_f32 v165, v165, v16, v16
    v_fma_f32 v166, v166, v16, v16
    v_fma_f32 v167, v167, v16, v16
    v_rcp_f32 v160, v160
    v_rcp_f32 v161, v161
    v_rcp_f32 v162, v162
    v_rcp_f32 v163, v163
    v_rcp_f32 v164, v164
    v_rcp_f32 v165, v165
    v_rcp_f32 v166, v166
    v_rcp_f32 v167, v167
    v_mul_f32 v160, v160, v96
    v_mul_f32 v161, v161, v97
    v_mul_f32 v162, v162, v98
    v_mul_f32 v163, v163, v99
    v_mul_f32 v164, v164, v100
    v_mul_f32 v165, v165, v101
    v_mul_f32 v166, v166, v102
    v_mul_f32 v167, v167, v103
    v_cvt_pk_bf16_f32 v184, v160, v161
    v_cvt_pk_bf16_f32 v185, v162, v163
    v_cvt_pk_bf16_f32 v186, v164, v165
    v_cvt_pk_bf16_f32 v187, v166, v167
    buffer_store_dwordx4 v[184:187], v31, s[68:71], s0 offen offset:2048 sc1
    s_add_u32 m0, s35, 4096
    s_add_u32 s82, s5, 49152
    buffer_load_dwordx4 v248, s[52:55], s82 offen offset:0 lds
    v_mul_f32 v168, v14, v104
    v_mul_f32 v169, v14, v105
    v_mul_f32 v170, v14, v106
    v_mul_f32 v171, v14, v107
    v_mul_f32 v172, v14, v108
    v_mul_f32 v173, v14, v109
    v_mul_f32 v174, v14, v110
    v_mul_f32 v175, v14, v111
    v_exp_f32 v168, v168
    v_exp_f32 v169, v169
    v_exp_f32 v170, v170
    v_exp_f32 v171, v171
    v_exp_f32 v172, v172
    v_exp_f32 v173, v173
    v_exp_f32 v174, v174
    v_exp_f32 v175, v175
    v_fma_f32 v168, v168, v16, v16
    v_fma_f32 v169, v169, v16, v16
    v_fma_f32 v170, v170, v16, v16
    v_fma_f32 v171, v171, v16, v16
    v_fma_f32 v172, v172, v16, v16
    v_fma_f32 v173, v173, v16, v16
    v_fma_f32 v174, v174, v16, v16
    v_fma_f32 v175, v175, v16, v16
    v_rcp_f32 v168, v168
    v_rcp_f32 v169, v169
    v_rcp_f32 v170, v170
    v_rcp_f32 v171, v171
    v_rcp_f32 v172, v172
    v_rcp_f32 v173, v173
    v_rcp_f32 v174, v174
    v_rcp_f32 v175, v175
    v_mul_f32 v168, v168, v104
    v_mul_f32 v169, v169, v105
    v_mul_f32 v170, v170, v106
    v_mul_f32 v171, v171, v107
    v_mul_f32 v172, v172, v108
    v_mul_f32 v173, v173, v109
    v_mul_f32 v174, v174, v110
    v_mul_f32 v175, v175, v111
    v_cvt_pk_bf16_f32 v188, v168, v169
    v_cvt_pk_bf16_f32 v189, v170, v171
    v_cvt_pk_bf16_f32 v190, v172, v173
    v_cvt_pk_bf16_f32 v191, v174, v175
    buffer_store_dwordx4 v[188:191], v31, s[68:71], s0 offen offset:3072 sc1
    buffer_load_dwordx4 v253, s[52:55], s82 offen offset:1024 lds
    v_mul_f32 v160, v14, v112
    v_mul_f32 v161, v14, v113
    v_mul_f32 v162, v14, v114
    v_mul_f32 v163, v14, v115
    v_mul_f32 v164, v14, v116
    v_mul_f32 v165, v14, v117
    v_mul_f32 v166, v14, v118
    v_mul_f32 v167, v14, v119
    v_exp_f32 v160, v160
    v_exp_f32 v161, v161
    v_exp_f32 v162, v162
    v_exp_f32 v163, v163
    v_exp_f32 v164, v164
    v_exp_f32 v165, v165
    v_exp_f32 v166, v166
    v_exp_f32 v167, v167
    v_fma_f32 v160, v160, v16, v16
    v_fma_f32 v161, v161, v16, v16
    v_fma_f32 v162, v162, v16, v16
    v_fma_f32 v163, v163, v16, v16
    v_fma_f32 v164, v164, v16, v16
    v_fma_f32 v165, v165, v16, v16
    v_fma_f32 v166, v166, v16, v16
    v_fma_f32 v167, v167, v16, v16
    v_rcp_f32 v160, v160
    v_rcp_f32 v161, v161
    v_rcp_f32 v162, v162
    v_rcp_f32 v163, v163
    v_rcp_f32 v164, v164
    v_rcp_f32 v165, v165
    v_rcp_f32 v166, v166
    v_rcp_f32 v167, v167
    v_mul_f32 v160, v160, v112
    v_mul_f32 v161, v161, v113
    v_mul_f32 v162, v162, v114
    v_mul_f32 v163, v163, v115
    v_mul_f32 v164, v164, v116
    v_mul_f32 v165, v165, v117
    v_mul_f32 v166, v166, v118
    v_mul_f32 v167, v167, v119
    v_cvt_pk_bf16_f32 v192, v160, v161
    v_cvt_pk_bf16_f32 v193, v162, v163
    v_cvt_pk_bf16_f32 v194, v164, v165
    v_cvt_pk_bf16_f32 v195, v166, v167
    buffer_store_dwordx4 v[192:195], v7, s[68:71], s1 offen offset:0 sc1
    s_add_u32 m0, s35, 6144
    s_add_u32 s82, s5, 65536
    buffer_load_dwordx4 v248, s[52:55], s82 offen offset:0 lds
    v_mul_f32 v168, v14, v120
    v_mul_f32 v169, v14, v121
    v_mul_f32 v170, v14, v122
    v_mul_f32 v171, v14, v123
    v_mul_f32 v172, v14, v124
    v_mul_f32 v173, v14, v125
    v_mul_f32 v174, v14, v126
    v_mul_f32 v175, v14, v127
    v_exp_f32 v168, v168
    v_exp_f32 v169, v169
    v_exp_f32 v170, v170
    v_exp_f32 v171, v171
    v_exp_f32 v172, v172
    v_exp_f32 v173, v173
    v_exp_f32 v174, v174
    v_exp_f32 v175, v175
    v_fma_f32 v168, v168, v16, v16
    v_fma_f32 v169, v169, v16, v16
    v_fma_f32 v170, v170, v16, v16
    v_fma_f32 v171, v171, v16, v16
    v_fma_f32 v172, v172, v16, v16
    v_fma_f32 v173, v173, v16, v16
    v_fma_f32 v174, v174, v16, v16
    v_fma_f32 v175, v175, v16, v16
    v_rcp_f32 v168, v168
    v_rcp_f32 v169, v169
    v_rcp_f32 v170, v170
    v_rcp_f32 v171, v171
    v_rcp_f32 v172, v172
    v_rcp_f32 v173, v173
    v_rcp_f32 v174, v174
    v_rcp_f32 v175, v175
    v_mul_f32 v168, v168, v120
    v_mul_f32 v169, v169, v121
    v_mul_f32 v170, v170, v122
    v_mul_f32 v171, v171, v123
    v_mul_f32 v172, v172, v124
    v_mul_f32 v173, v173, v125
    v_mul_f32 v174, v174, v126
    v_mul_f32 v175, v175, v127
    v_cvt_pk_bf16_f32 v196, v168, v169
    v_cvt_pk_bf16_f32 v197, v170, v171
    v_cvt_pk_bf16_f32 v198, v172, v173
    v_cvt_pk_bf16_f32 v199, v174, v175
    buffer_store_dwordx4 v[196:199], v7, s[68:71], s1 offen offset:1024 sc1
    buffer_load_dwordx4 v253, s[52:55], s82 offen offset:1024 lds
    s_add_u32 m0, s35, 8192
    s_add_u32 s82, s5, 81920
    buffer_load_dwordx4 v248, s[52:55], s82 offen offset:0 lds
    buffer_load_dwordx4 v253, s[52:55], s82 offen offset:1024 lds
    s_add_u32 m0, s35, 10240
    s_add_u32 s82, s5, 98304
    buffer_load_dwordx4 v248, s[52:55], s82 offen offset:0 lds
    buffer_load_dwordx4 v253, s[52:55], s82 offen offset:1024 lds
    s_add_u32 m0, s35, 12288
    s_add_u32 s82, s5, 114688
    buffer_load_dwordx4 v248, s[52:55], s82 offen offset:0 lds
    buffer_load_dwordx4 v253, s[52:55], s82 offen offset:1024 lds
    s_add_u32 m0, s35, 14336
    s_add_u32 s82, s5, 131072
    buffer_load_dwordx4 v248, s[52:55], s82 offen offset:0 lds
    buffer_load_dwordx4 v253, s[52:55], s82 offen offset:1024 lds
    s_add_u32 m0, s35, 16384
    s_add_u32 s82, s5, 147456
    buffer_load_dwordx4 v248, s[52:55], s82 offen offset:0 lds
    buffer_load_dwordx4 v253, s[52:55], s82 offen offset:1024 lds
    s_add_u32 m0, s35, 18432
    s_add_u32 s82, s5, 163840
    buffer_load_dwordx4 v248, s[52:55], s82 offen offset:0 lds
    buffer_load_dwordx4 v253, s[52:55], s82 offen offset:1024 lds
    s_waitcnt vmcnt(13)
    s_waitcnt lgkmcnt(0)
    s_mov_b32 s33, s78
    s_atomic_swap s33, s[26:27], 0x0
    v_lshlrev_b32 v2, 4, v1
    v_add_u32 v3, 155648, v2
    s_xor_b32 s80, s76, 1
    s_mul_i32 s3, s80, 311296
    s_add_u32 s3, s3, s100
    s_add_u32 s3, s3, 5242880
    s_mul_i32 s6, s76, 311296
    s_add_u32 s6, s6, s100
    s_add_u32 s6, s6, 5242880
    ds_read_b64_tr_b16 v[128:129], v249 offset:0
    ds_read_b64_tr_b16 v[130:131], v249 offset:512
    ds_read_b64_tr_b16 v[132:133], v250 offset:0
    ds_read_b64_tr_b16 v[134:135], v250 offset:512
    ds_read_b64_tr_b16 v[136:137], v251 offset:0
    ds_read_b64_tr_b16 v[138:139], v251 offset:512
    ds_read_b64_tr_b16 v[140:141], v252 offset:0
    ds_read_b64_tr_b16 v[142:143], v252 offset:512
    ds_read_b64_tr_b16 v[144:145], v251 offset:2048
    ds_read_b64_tr_b16 v[146:147], v251 offset:2560
    ds_read_b64_tr_b16 v[148:149], v252 offset:2048
    ds_read_b64_tr_b16 v[150:151], v252 offset:2560
    ds_read_b64_tr_b16 v[152:153], v251 offset:4096
    ds_read_b64_tr_b16 v[154:155], v251 offset:4608
    ds_read_b64_tr_b16 v[156:157], v252 offset:4096
    ds_read_b64_tr_b16 v[158:159], v252 offset:4608
    s_waitcnt vmcnt(12)
    ds_read_b64_tr_b16 v[160:161], v251 offset:6144
    ds_read_b64_tr_b16 v[162:163], v251 offset:6656
    ds_read_b64_tr_b16 v[164:165], v252 offset:6144
    ds_read_b64_tr_b16 v[166:167], v252 offset:6656
    s_waitcnt vmcnt(10)
    ds_read_b64_tr_b16 v[168:169], v251 offset:8192
    ds_read_b64_tr_b16 v[170:171], v251 offset:8704
    ds_read_b64_tr_b16 v[172:173], v252 offset:8192
    ds_read_b64_tr_b16 v[174:175], v252 offset:8704
    s_waitcnt vmcnt(8)
    ds_read_b64_tr_b16 v[176:177], v251 offset:10240
    ds_read_b64_tr_b16 v[178:179], v251 offset:10752
    ds_read_b64_tr_b16 v[180:181], v252 offset:10240
    ds_read_b64_tr_b16 v[182:183], v252 offset:10752
    s_waitcnt vmcnt(6)
    ds_read_b64_tr_b16 v[184:185], v251 offset:12288
    ds_read_b64_tr_b16 v[186:187], v251 offset:12800
    ds_read_b64_tr_b16 v[188:189], v252 offset:12288
    ds_read_b64_tr_b16 v[190:191], v252 offset:12800
    s_waitcnt vmcnt(4)
    ds_read_b64_tr_b16 v[192:193], v251 offset:14336
    ds_read_b64_tr_b16 v[194:195], v251 offset:14848
    ds_read_b64_tr_b16 v[196:197], v252 offset:14336
    ds_read_b64_tr_b16 v[198:199], v252 offset:14848
    s_waitcnt vmcnt(2)
    ds_read_b64_tr_b16 v[200:201], v251 offset:16384
    ds_read_b64_tr_b16 v[202:203], v251 offset:16896
    ds_read_b64_tr_b16 v[204:205], v252 offset:16384
    ds_read_b64_tr_b16 v[206:207], v252 offset:16896
    s_waitcnt vmcnt(0)
    ds_read_b64_tr_b16 v[208:209], v251 offset:18432
    ds_read_b64_tr_b16 v[210:211], v251 offset:18944
    ds_read_b64_tr_b16 v[212:213], v252 offset:18432
    ds_read_b64_tr_b16 v[214:215], v252 offset:18944
    s_load_dwordx4 s[8:11], s[20:21], 0 glc
    s_load_dwordx4 s[12:15], s[20:21], 128 glc
    s_load_dwordx4 s[16:19], s[20:21], 256 glc
    s_mov_b32 s83, 131072
L_fp_43:
    s_waitcnt lgkmcnt(0)
    s_cmp_lg_u64 s[8:9], s[78:79]
    s_cbranch_scc1 L_fr_45
    s_cmp_lg_u64 s[10:11], s[78:79]
    s_cbranch_scc1 L_fr_45
    s_cmp_lg_u64 s[12:13], s[78:79]
    s_cbranch_scc1 L_fr_45
    s_cmp_lg_u64 s[14:15], s[78:79]
    s_cbranch_scc1 L_fr_45
    s_cmp_lg_u64 s[16:17], s[78:79]
    s_cbranch_scc1 L_fr_45
    s_cmp_lg_u64 s[18:19], s[78:79]
    s_cbranch_scc1 L_fr_45
L_fd_44:
    s_add_u32 s39, s3, 0
    buffer_load_dwordx4 v[16:19], v2, s[68:71], s39 offen sc1
    buffer_load_dwordx4 v[20:23], v3, s[68:71], s39 offen sc1
    s_add_u32 s39, s3, 1024
    buffer_load_dwordx4 v[24:27], v2, s[68:71], s39 offen sc1
    buffer_load_dwordx4 v[28:31], v3, s[68:71], s39 offen sc1
    s_add_u32 s39, s3, 2048
    buffer_load_dwordx4 v[32:35], v2, s[68:71], s39 offen sc1
    buffer_load_dwordx4 v[36:39], v3, s[68:71], s39 offen sc1
    s_add_u32 s39, s3, 3072
    buffer_load_dwordx4 v[40:43], v2, s[68:71], s39 offen sc1
    buffer_load_dwordx4 v[44:47], v3, s[68:71], s39 offen sc1
    s_waitcnt lgkmcnt(0)
    s_waitcnt vmcnt(7)
    v_mfma_f32_32x32x16_bf16 v[64:79], v[128:131], v[16:19], 0
    v_readfirstlane_b32 s82, v244
    v_lshrrev_b32 v234, 3, v1
    v_and_b32 v235, 3, v234
    v_lshrrev_b32 v234, 2, v234
    v_lshl_add_u32 v235, v234, 3, v235
    v_mfma_f32_32x32x16_bf16 v[96:111], v[132:135], v[16:19], 0
    s_add_u32 s39, s3, 4096
    buffer_load_dwordx4 v[16:19], v2, s[68:71], s39 offen sc1
    v_and_b32 v234, 7, v1
    v_lshlrev_b32 v234, 4, v234
    v_lshl_add_u32 v234, v235, 10, v234
    s_lshl_b32 s80, s76, 6
    s_add_u32 s82, s82, s80
    s_waitcnt vmcnt(7)
    v_mfma_f32_32x32x16_bf16 v[80:95], v[128:131], v[20:23], 0
    s_lshl_b32 s80, s82, 10
    s_lshl_b32 s81, s77, 7
    s_add_u32 s80, s80, s81
    s_mov_b32 m0, s34
    s_nop 0
    buffer_load_dwordx4 v234, s[40:43], s80 offen lds
    v_mfma_f32_32x32x16_bf16 v[112:127], v[132:135], v[20:23], 0
    buffer_load_dwordx4 v[20:23], v3, s[68:71], s39 offen sc1
    s_add_u32 s80, s80, 31744
    buffer_load_dwordx4 v234, s[40:43], s80 offen offset:1024 lds
    v_and_b32 v235, 3, v1
    v_bfe_u32 v236, v1, 2, 1
    v_bfe_u32 v237, v1, 3, 1
    s_waitcnt vmcnt(9)
    v_mfma_f32_32x32x16_bf16 v[64:79], v[136:139], v[24:27], v[64:79]
    v_lshlrev_b32 v235, 3, v235
    v_lshl_add_u32 v235, v236, 7, v235
    v_lshl_add_u32 v235, v237, 9, v235
    s_lshr_b32 s80, s82, 3
    s_lshl_b32 s80, s80, 7
    v_mfma_f32_32x32x16_bf16 v[96:111], v[140:143], v[24:27], v[96:111]
    s_add_u32 s39, s3, 5120
    buffer_load_dwordx4 v[24:27], v2, s[68:71], s39 offen sc1
    s_and_b32 s81, s82, 7
    s_lshl_b32 s81, s81, 3
    s_add_u32 s80, s80, s81
    s_add_u32 s80, s80, 32768
    s_mov_b64 exec, 0xffff
    buffer_load_dword v245, v235, s[68:71], s80 offen sc1
    s_mov_b64 exec, -1
    s_waitcnt vmcnt(10)
    v_mfma_f32_32x32x16_bf16 v[80:95], v[136:139], v[28:31], v[80:95]
    v_xor_b32 v12, v242, v243
    v_and_b32 v12, 7, v12
    v_lshlrev_b32 v12, 4, v12
    v_lshl_add_u32 v12, v242, 7, v12
    v_lshrrev_b32 v13, 3, v243
    v_mfma_f32_32x32x16_bf16 v[112:127], v[140:143], v[28:31], v[112:127]
    buffer_load_dwordx4 v[28:31], v3, s[68:71], s39 offen sc1
    v_lshl_add_u32 v12, v13, 12, v12
    v_add_u32 v13, 40960, v12
    v_add_u32 v14, 86016, v12
    v_lshlrev_b32 v15, 11, v244
    v_lshl_add_u32 v15, v243, 4, v15
    s_waitcnt vmcnt(10)
    v_mfma_f32_32x32x16_bf16 v[64:79], v[144:147], v[32:35], v[64:79]
    s_lshl_b32 s80, s76, 17
    s_lshl_b32 s81, s77, 8
    s_add_u32 s4, s80, s81
    s_lshl_b32 s80, s76, 3
    s_add_u32 s80, s80, s77
    v_mfma_f32_32x32x16_bf16 v[96:111], v[148:151], v[32:35], v[96:111]
    s_add_u32 s39, s3, 6144
    buffer_load_dwordx4 v[32:35], v2, s[68:71], s39 offen sc1
    s_lshl_b32 s81, s80, 2
    s_add_u32 s81, s81, s73
    s_lshl_b32 s81, s81, 12
    s_add_u32 s23, s81, 1048576
    s_xor_b32 s81, s81, 131072
    s_waitcnt vmcnt(10)
    v_mfma_f32_32x32x16_bf16 v[80:95], v[144:147], v[36:39], v[80:95]
    s_add_u32 s22, s81, 1048576
    s_lshl_b32 s80, s80, 7
    s_lshl_b32 s81, s73, 2
    s_add_u32 s80, s80, s81
    s_add_u32 s81, s80, 983040
    v_mfma_f32_32x32x16_bf16 v[112:127], v[148:151], v[36:39], v[112:127]
    buffer_load_dwordx4 v[36:39], v3, s[68:71], s39 offen sc1
    s_add_u32 s20, s36, s81
    s_addc_u32 s21, s37, 0
    s_xor_b32 s80, s80, 1024
    s_add_u32 s80, s80, 983040
    s_add_u32 s26, s36, s80
    s_addc_u32 s27, s37, 0
    v_lshrrev_b32 v5, 5, v1
    v_and_b32 v6, 7, v1
    v_and_b32 v4, 31, v1
    v_xor_b32 v5, v5, v6
    v_lshlrev_b32 v5, 4, v5
    v_lshl_add_u32 v4, v4, 7, v5
    v_add_u32 v4, s35, v4
    v_xor_b32 v5, 32, v4
    v_xor_b32 v6, 64, v4
    v_xor_b32 v7, 0x60, v4
    v_mov_b32 v8, 160768
    v_mov_b32 v9, 1
    s_waitcnt vmcnt(10)
    v_mfma_f32_32x32x16_bf16 v[64:79], v[152:155], v[40:43], v[64:79]
    v_mfma_f32_32x32x16_bf16 v[96:111], v[156:159], v[40:43], v[96:111]
    s_add_u32 s39, s3, 7168
    buffer_load_dwordx4 v[40:43], v2, s[68:71], s39 offen sc1
    s_waitcnt vmcnt(10)
    v_mfma_f32_32x32x16_bf16 v[80:95], v[152:155], v[44:47], v[80:95]
    v_mfma_f32_32x32x16_bf16 v[112:127], v[156:159], v[44:47], v[112:127]
    buffer_load_dwordx4 v[44:47], v3, s[68:71], s39 offen sc1
    s_waitcnt vmcnt(10)
    v_mfma_f32_32x32x16_bf16 v[64:79], v[160:163], v[16:19], v[64:79]
    v_mfma_f32_32x32x16_bf16 v[96:111], v[164:167], v[16:19], v[96:111]
    s_add_u32 s39, s3, 8192
    buffer_load_dwordx4 v[16:19], v2, s[68:71], s39 offen sc1
    s_waitcnt vmcnt(9)
    v_mfma_f32_32x32x16_bf16 v[80:95], v[160:163], v[20:23], v[80:95]
    v_mfma_f32_32x32x16_bf16 v[112:127], v[164:167], v[20:23], v[112:127]
    s_add_u32 s39, s3, 9216
    buffer_load_dwordx4 v[20:23], v2, s[68:71], s39 offen sc1
    s_waitcnt vmcnt(8)
    v_mfma_f32_32x32x16_bf16 v[64:79], v[168:171], v[24:27], v[64:79]
    v_mfma_f32_32x32x16_bf16 v[96:111], v[172:175], v[24:27], v[96:111]
    s_add_u32 s39, s3, 10240
    buffer_load_dwordx4 v[24:27], v2, s[68:71], s39 offen sc1
    s_waitcnt vmcnt(7)
    v_mfma_f32_32x32x16_bf16 v[80:95], v[168:171], v[28:31], v[80:95]
    v_mfma_f32_32x32x16_bf16 v[112:127], v[172:175], v[28:31], v[112:127]
    s_add_u32 s39, s3, 8192
    buffer_load_dwordx4 v[28:31], v3, s[68:71], s39 offen sc1
    s_waitcnt vmcnt(7)
    v_mfma_f32_32x32x16_bf16 v[64:79], v[176:179], v[32:35], v[64:79]
    v_mfma_f32_32x32x16_bf16 v[96:111], v[180:183], v[32:35], v[96:111]
    s_add_u32 s39, s3, 9216
    buffer_load_dwordx4 v[32:35], v3, s[68:71], s39 offen sc1
    s_waitcnt vmcnt(7)
    v_mfma_f32_32x32x16_bf16 v[80:95], v[176:179], v[36:39], v[80:95]
    v_mfma_f32_32x32x16_bf16 v[112:127], v[180:183], v[36:39], v[112:127]
    s_add_u32 s39, s3, 10240
    buffer_load_dwordx4 v[36:39], v3, s[68:71], s39 offen sc1
    s_waitcnt vmcnt(7)
    v_mfma_f32_32x32x16_bf16 v[64:79], v[184:187], v[40:43], v[64:79]
    v_mfma_f32_32x32x16_bf16 v[96:111], v[188:191], v[40:43], v[96:111]
    s_add_u32 s39, s6, 0
    buffer_load_dwordx4 v[40:43], v2, s[68:71], s39 offen sc1
    s_waitcnt vmcnt(7)
    v_mfma_f32_32x32x16_bf16 v[80:95], v[184:187], v[44:47], v[80:95]
    v_mfma_f32_32x32x16_bf16 v[112:127], v[188:191], v[44:47], v[112:127]
    buffer_load_dwordx4 v[44:47], v3, s[68:71], s39 offen sc1
    s_waitcnt vmcnt(7)
    v_mfma_f32_32x32x16_bf16 v[64:79], v[192:195], v[16:19], v[64:79]
    v_mfma_f32_32x32x16_bf16 v[96:111], v[196:199], v[16:19], v[96:111]
    s_add_u32 s39, s6, 1024
    buffer_load_dwordx4 v[16:19], v2, s[68:71], s39 offen sc1
    s_waitcnt vmcnt(7)
    v_mfma_f32_32x32x16_bf16 v[64:79], v[200:203], v[20:23], v[64:79]
    v_mfma_f32_32x32x16_bf16 v[96:111], v[204:207], v[20:23], v[96:111]
    buffer_load_dwordx4 v[20:23], v3, s[68:71], s39 offen sc1
    s_waitcnt vmcnt(7)
    v_mfma_f32_32x32x16_bf16 v[64:79], v[208:211], v[24:27], v[64:79]
    v_mfma_f32_32x32x16_bf16 v[96:111], v[212:215], v[24:27], v[96:111]
    s_add_u32 s39, s6, 2048
    buffer_load_dwordx4 v[24:27], v2, s[68:71], s39 offen sc1
    s_waitcnt vmcnt(7)
    v_mfma_f32_32x32x16_bf16 v[80:95], v[192:195], v[28:31], v[80:95]
    v_mfma_f32_32x32x16_bf16 v[112:127], v[196:199], v[28:31], v[112:127]
    s_nop 5
    ds_write_b128 v4, v[64:67] offset:0
    ds_write_b128 v5, v[68:71] offset:0
    ds_write_b128 v6, v[72:75] offset:0
    ds_write_b128 v7, v[76:79] offset:0
    buffer_load_dwordx4 v[28:31], v3, s[68:71], s39 offen sc1
    s_waitcnt vmcnt(7)
    v_mfma_f32_32x32x16_bf16 v[80:95], v[200:203], v[32:35], v[80:95]
    ds_write_b128 v4, v[96:99] offset:4096
    ds_write_b128 v5, v[100:103] offset:4096
    ds_write_b128 v6, v[104:107] offset:4096
    ds_write_b128 v7, v[108:111] offset:4096
    v_mfma_f32_32x32x16_bf16 v[112:127], v[204:207], v[32:35], v[112:127]
    s_add_u32 s39, s6, 3072
    buffer_load_dwordx4 v[32:35], v2, s[68:71], s39 offen sc1
    s_waitcnt vmcnt(7)
    v_mfma_f32_32x32x16_bf16 v[80:95], v[208:211], v[36:39], v[80:95]
    v_mfma_f32_32x32x16_bf16 v[112:127], v[212:215], v[36:39], v[112:127]
    buffer_load_dwordx4 v[36:39], v3, s[68:71], s39 offen sc1
    s_nop 9
    ds_write_b128 v4, v[80:83] offset:8192
    ds_write_b128 v5, v[84:87] offset:8192
    ds_write_b128 v6, v[88:91] offset:8192
    ds_write_b128 v7, v[92:95] offset:8192
    ds_write_b128 v4, v[112:115] offset:12288
    ds_write_b128 v5, v[116:119] offset:12288
    ds_write_b128 v6, v[120:123] offset:12288
    ds_write_b128 v7, v[124:127] offset:12288
    s_mov_b64 exec, 1
    ds_add_u32 v8, v9 offset:40
    s_mov_b64 exec, -1
    s_mov_b32 s101, 0x1000000
L_sw_46:
    ds_read_b32 v10, v8 offset:40
    s_sub_u32 s101, s101, 1
    s_cselect_b32 s98, 0, 4
    s_waitcnt lgkmcnt(0)
    v_readfirstlane_b32 s80, v10
    s_nop 0
    s_cmp_lt_u32 s80, s98
    s_cbranch_scc1 L_sw_46
    ds_read_b128 v[64:67], v12 offset:0
    ds_read_b128 v[68:71], v12 offset:20480
    ds_read_b128 v[72:75], v13 offset:0
    ds_read_b128 v[76:79], v13 offset:20480
    ds_read_b128 v[80:83], v12 offset:2048
    ds_read_b128 v[84:87], v12 offset:22528
    ds_read_b128 v[88:91], v13 offset:2048
    ds_read_b128 v[92:95], v13 offset:22528
    ds_read_b128 v[96:99], v12 offset:8192
    ds_read_b128 v[100:103], v12 offset:28672
    ds_read_b128 v[104:107], v13 offset:8192
    ds_read_b128 v[108:111], v13 offset:28672
    ds_read_b128 v[112:115], v12 offset:10240
    ds_read_b128 v[116:119], v12 offset:30720
    ds_read_b128 v[120:123], v13 offset:10240
    ds_read_b128 v[124:127], v13 offset:30720
    s_waitcnt lgkmcnt(12)
    v_add_f32 v64, v64, v68
    v_add_f32 v65, v65, v69
    v_add_f32 v66, v66, v70
    v_add_f32 v67, v67, v71
    v_add_f32 v72, v72, v76
    v_add_f32 v73, v73, v77
    v_add_f32 v74, v74, v78
    v_add_f32 v75, v75, v79
    v_add_f32 v64, v64, v72
    v_add_f32 v65, v65, v73
    v_add_f32 v66, v66, v74
    v_add_f32 v67, v67, v75
    v_cvt_pk_bf16_f32 v230, v64, v65
    v_cvt_pk_bf16_f32 v231, v66, v67
    s_waitcnt lgkmcnt(8)
    v_add_f32 v80, v80, v84
    v_add_f32 v81, v81, v85
    v_add_f32 v82, v82, v86
    v_add_f32 v83, v83, v87
    v_add_f32 v88, v88, v92
    v_add_f32 v89, v89, v93
    v_add_f32 v90, v90, v94
    v_add_f32 v91, v91, v95
    v_add_f32 v80, v80, v88
    v_add_f32 v81, v81, v89
    v_add_f32 v82, v82, v90
    v_add_f32 v83, v83, v91
    v_cvt_pk_bf16_f32 v232, v80, v81
    v_cvt_pk_bf16_f32 v233, v82, v83
    s_waitcnt lgkmcnt(4)
    v_add_f32 v96, v96, v100
    v_add_f32 v97, v97, v101
    v_add_f32 v98, v98, v102
    v_add_f32 v99, v99, v103
    v_add_f32 v104, v104, v108
    v_add_f32 v105, v105, v109
    v_add_f32 v106, v106, v110
    v_add_f32 v107, v107, v111
    v_add_f32 v96, v96, v104
    v_add_f32 v97, v97, v105
    v_add_f32 v98, v98, v106
    v_add_f32 v99, v99, v107
    v_cvt_pk_bf16_f32 v234, v96, v97
    v_cvt_pk_bf16_f32 v235, v98, v99
    s_waitcnt lgkmcnt(0)
    s_mov_b64 exec, 1
    ds_add_u32 v8, v9 offset:44
    s_mov_b64 exec, -1
    v_add_f32 v112, v112, v116
    v_add_f32 v113, v113, v117
    v_add_f32 v114, v114, v118
    v_add_f32 v115, v115, v119
    v_add_f32 v120, v120, v124
    v_add_f32 v121, v121, v125
    v_add_f32 v122, v122, v126
    v_add_f32 v123, v123, v127
    v_add_f32 v112, v112, v120
    v_add_f32 v113, v113, v121
    v_add_f32 v114, v114, v122
    v_add_f32 v115, v115, v123
    v_cvt_pk_bf16_f32 v236, v112, v113
    v_cvt_pk_bf16_f32 v237, v114, v115
    buffer_store_dwordx4 v[230:233], v2, s[68:71], s22 offen offset:0 sc1
    buffer_store_dwordx4 v[234:237], v2, s[68:71], s22 offen offset:1024 sc1
    s_waitcnt vmcnt(9)
    v_mfma_f32_32x32x16_bf16 v[64:79], v[128:131], v[40:43], 0
    v_mfma_f32_32x32x16_bf16 v[96:111], v[132:135], v[40:43], 0
    s_add_u32 s39, s6, 4096
    buffer_load_dwordx4 v[40:43], v2, s[68:71], s39 offen sc1
    s_waitcnt vmcnt(9)
    v_mfma_f32_32x32x16_bf16 v[80:95], v[128:131], v[44:47], 0
    v_lshrrev_b32 v240, 4, v1
    v_lshlrev_b32 v241, 2, v240
    v_lshlrev_b32 v240, 7, v240
    v_lshl_add_u32 v240, v243, 3, v240
    v_add_u32 v240, s34, v240
    v_mfma_f32_32x32x16_bf16 v[112:127], v[132:135], v[44:47], 0
    buffer_load_dwordx4 v[44:47], v3, s[68:71], s39 offen sc1
    v_lshlrev_b32 v246, 3, v243
    v_add_u32 v246, 163264, v246
    ds_read_b64 v[228:229], v246
    ds_read_b64 v[216:217], v240 offset:0
    ds_bpermute_b32 v224, v241, v245 offset:0
    s_waitcnt vmcnt(9)
    v_mfma_f32_32x32x16_bf16 v[64:79], v[136:139], v[16:19], v[64:79]
    ds_read_b64 v[218:219], v240 offset:512
    ds_bpermute_b32 v225, v241, v245 offset:16
    ds_read_b64 v[220:221], v240 offset:1024
    ds_bpermute_b32 v226, v241, v245 offset:32
    ds_read_b64 v[222:223], v240 offset:1536
    v_mfma_f32_32x32x16_bf16 v[96:111], v[140:143], v[16:19], v[96:111]
    s_add_u32 s39, s6, 5120
    buffer_load_dwordx4 v[16:19], v2, s[68:71], s39 offen sc1
    ds_bpermute_b32 v227, v241, v245 offset:48
    s_waitcnt lgkmcnt(0)
    v_lshlrev_b32 v230, 16, v228
    v_and_b32 v231, s38, v228
    v_lshlrev_b32 v232, 16, v229
    v_and_b32 v233, s38, v229
    s_waitcnt vmcnt(9)
    v_mfma_f32_32x32x16_bf16 v[80:95], v[136:139], v[20:23], v[80:95]
    v_lshlrev_b32 v241, 16, v224
    v_lshlrev_b32 v248, 16, v216
    v_rcp_f32 v241, v241
    v_and_b32 v249, s38, v216
    v_lshlrev_b32 v250, 16, v217
    v_mfma_f32_32x32x16_bf16 v[112:127], v[140:143], v[20:23], v[112:127]
    buffer_load_dwordx4 v[20:23], v3, s[68:71], s39 offen sc1
    v_and_b32 v251, s38, v217
    v_and_b32 v240, s38, v224
    v_sub_f32 v234, v248, v240
    v_sub_f32 v235, v249, v240
    v_sub_f32 v236, v250, v240
    s_waitcnt vmcnt(9)
    v_mfma_f32_32x32x16_bf16 v[64:79], v[144:147], v[24:27], v[64:79]
    v_sub_f32 v237, v251, v240
    v_cvt_pk_bf16_f32 v238, v234, v235
    v_cvt_pk_bf16_f32 v239, v236, v237
    v_lshlrev_b32 v234, 16, v238
    v_and_b32 v235, s38, v238
    v_mfma_f32_32x32x16_bf16 v[96:111], v[148:151], v[24:27], v[96:111]
    s_add_u32 s39, s6, 6144
    buffer_load_dwordx4 v[24:27], v2, s[68:71], s39 offen sc1
    v_lshlrev_b32 v236, 16, v239
    v_and_b32 v237, s38, v239
    v_mul_f32 v234, v234, v241
    v_mul_f32 v235, v235, v241
    v_mul_f32 v236, v236, v241
    s_waitcnt vmcnt(9)
    v_mfma_f32_32x32x16_bf16 v[80:95], v[144:147], v[28:31], v[80:95]
    v_mul_f32 v237, v237, v241
    v_cvt_pk_bf16_f32 v238, v234, v235
    v_cvt_pk_bf16_f32 v239, v236, v237
    v_lshlrev_b32 v234, 16, v238
    v_and_b32 v235, s38, v238
    v_mfma_f32_32x32x16_bf16 v[112:127], v[148:151], v[28:31], v[112:127]
    buffer_load_dwordx4 v[28:31], v3, s[68:71], s39 offen sc1
    v_lshlrev_b32 v236, 16, v239
    v_and_b32 v237, s38, v239
    v_mul_f32 v234, v234, v230
    v_mul_f32 v235, v235, v231
    v_mul_f32 v236, v236, v232
    s_waitcnt vmcnt(9)
    v_mfma_f32_32x32x16_bf16 v[64:79], v[152:155], v[32:35], v[64:79]
    v_mul_f32 v237, v237, v233
    v_cvt_pk_bf16_f32 v238, v234, v235
    v_cvt_pk_bf16_f32 v239, v236, v237
    v_lshlrev_b32 v234, 16, v238
    v_and_b32 v235, s38, v238
    v_mfma_f32_32x32x16_bf16 v[96:111], v[156:159], v[32:35], v[96:111]
    s_add_u32 s39, s6, 7168
    buffer_load_dwordx4 v[32:35], v2, s[68:71], s39 offen sc1
    v_lshlrev_b32 v236, 16, v239
    v_and_b32 v237, s38, v239
    v_add_f32 v248, v248, v234
    v_add_f32 v249, v249, v235
    v_add_f32 v250, v250, v236
    s_waitcnt vmcnt(7)
    s_waitcnt lgkmcnt(0)
    s_mov_b32 s33, s78
    s_atomic_swap s33, s[26:27], 0x0
    v_mfma_f32_32x32x16_bf16 v[80:95], v[152:155], v[36:39], v[80:95]
    v_add_f32 v251, v251, v237
    v_lshlrev_b32 v241, 16, v225
    v_lshlrev_b32 v252, 16, v218
    v_rcp_f32 v241, v241
    v_and_b32 v253, s38, v218
    v_mfma_f32_32x32x16_bf16 v[112:127], v[156:159], v[36:39], v[112:127]
    buffer_load_dwordx4 v[36:39], v3, s[68:71], s39 offen sc1
    v_lshlrev_b32 v247, 16, v219
    v_and_b32 v11, s38, v219
    v_and_b32 v240, s38, v225
    v_sub_f32 v234, v252, v240
    v_sub_f32 v235, v253, v240
    s_waitcnt vmcnt(7)
    v_mfma_f32_32x32x16_bf16 v[64:79], v[160:163], v[40:43], v[64:79]
    v_sub_f32 v236, v247, v240
    v_sub_f32 v237, v11, v240
    v_cvt_pk_bf16_f32 v238, v234, v235
    v_cvt_pk_bf16_f32 v239, v236, v237
    v_lshlrev_b32 v234, 16, v238
    v_mfma_f32_32x32x16_bf16 v[96:111], v[164:167], v[40:43], v[96:111]
    s_add_u32 s39, s6, 8192
    buffer_load_dwordx4 v[40:43], v2, s[68:71], s39 offen sc1
    v_and_b32 v235, s38, v238
    v_lshlrev_b32 v236, 16, v239
    v_and_b32 v237, s38, v239
    v_mul_f32 v234, v234, v241
    v_mul_f32 v235, v235, v241
    s_waitcnt vmcnt(7)
    v_mfma_f32_32x32x16_bf16 v[80:95], v[160:163], v[44:47], v[80:95]
    v_mul_f32 v236, v236, v241
    v_mul_f32 v237, v237, v241
    v_cvt_pk_bf16_f32 v238, v234, v235
    v_cvt_pk_bf16_f32 v239, v236, v237
    v_lshlrev_b32 v234, 16, v238
    v_mfma_f32_32x32x16_bf16 v[112:127], v[164:167], v[44:47], v[112:127]
    s_add_u32 s39, s6, 9216
    buffer_load_dwordx4 v[44:47], v2, s[68:71], s39 offen sc1
    v_and_b32 v235, s38, v238
    v_lshlrev_b32 v236, 16, v239
    v_and_b32 v237, s38, v239
    v_mul_f32 v234, v234, v230
    v_mul_f32 v235, v235, v231
    s_waitcnt vmcnt(7)
    v_mfma_f32_32x32x16_bf16 v[64:79], v[168:171], v[16:19], v[64:79]
    v_mul_f32 v236, v236, v232
    v_mul_f32 v237, v237, v233
    v_cvt_pk_bf16_f32 v238, v234, v235
    v_cvt_pk_bf16_f32 v239, v236, v237
    v_lshlrev_b32 v234, 16, v238
    v_mfma_f32_32x32x16_bf16 v[96:111], v[172:175], v[16:19], v[96:111]
    s_add_u32 s39, s6, 10240
    buffer_load_dwordx4 v[16:19], v2, s[68:71], s39 offen sc1
    v_and_b32 v235, s38, v238
    v_lshlrev_b32 v236, 16, v239
    v_and_b32 v237, s38, v239
    v_add_f32 v252, v252, v234
    v_add_f32 v253, v253, v235
    s_waitcnt vmcnt(7)
    v_mfma_f32_32x32x16_bf16 v[80:95], v[168:171], v[20:23], v[80:95]
    v_add_f32 v247, v247, v236
    v_add_f32 v11, v11, v237
    v_lshlrev_b32 v241, 16, v226
    v_lshlrev_b32 v216, 16, v220
    v_rcp_f32 v241, v241
    v_mfma_f32_32x32x16_bf16 v[112:127], v[172:175], v[20:23], v[112:127]
    s_add_u32 s39, s6, 8192
    buffer_load_dwordx4 v[20:23], v3, s[68:71], s39 offen sc1
    v_and_b32 v217, s38, v220
    v_lshlrev_b32 v224, 16, v221
    v_and_b32 v218, s38, v221
    v_and_b32 v240, s38, v226
    v_sub_f32 v234, v216, v240
    s_waitcnt vmcnt(7)
    v_mfma_f32_32x32x16_bf16 v[64:79], v[176:179], v[24:27], v[64:79]
    v_sub_f32 v235, v217, v240
    v_sub_f32 v236, v224, v240
    v_sub_f32 v237, v218, v240
    v_cvt_pk_bf16_f32 v238, v234, v235
    v_cvt_pk_bf16_f32 v239, v236, v237
    v_mfma_f32_32x32x16_bf16 v[96:111], v[180:183], v[24:27], v[96:111]
    s_add_u32 s39, s6, 9216
    buffer_load_dwordx4 v[24:27], v3, s[68:71], s39 offen sc1
    v_lshlrev_b32 v234, 16, v238
    v_and_b32 v235, s38, v238
    v_lshlrev_b32 v236, 16, v239
    v_and_b32 v237, s38, v239
    v_mul_f32 v234, v234, v241
    s_waitcnt vmcnt(7)
    v_mfma_f32_32x32x16_bf16 v[80:95], v[176:179], v[28:31], v[80:95]
    v_mul_f32 v235, v235, v241
    v_mul_f32 v236, v236, v241
    v_mul_f32 v237, v237, v241
    v_cvt_pk_bf16_f32 v238, v234, v235
    v_cvt_pk_bf16_f32 v239, v236, v237
    v_mfma_f32_32x32x16_bf16 v[112:127], v[180:183], v[28:31], v[112:127]
    s_add_u32 s39, s6, 10240
    buffer_load_dwordx4 v[28:31], v3, s[68:71], s39 offen sc1
    v_lshlrev_b32 v234, 16, v238
    v_and_b32 v235, s38, v238
    v_lshlrev_b32 v236, 16, v239
    v_and_b32 v237, s38, v239
    v_mul_f32 v234, v234, v230
    s_waitcnt vmcnt(7)
    v_mfma_f32_32x32x16_bf16 v[64:79], v[184:187], v[32:35], v[64:79]
    v_mul_f32 v235, v235, v231
    v_mul_f32 v236, v236, v232
    v_mul_f32 v237, v237, v233
    v_cvt_pk_bf16_f32 v238, v234, v235
    v_cvt_pk_bf16_f32 v239, v236, v237
    v_mfma_f32_32x32x16_bf16 v[96:111], v[188:191], v[32:35], v[96:111]
    v_lshlrev_b32 v234, 16, v238
    v_and_b32 v235, s38, v238
    v_lshlrev_b32 v236, 16, v239
    v_and_b32 v237, s38, v239
    v_add_f32 v216, v216, v234
    s_mov_b32 s101, 0x1000000
L_sw_47:
    ds_read_b32 v10, v8 offset:44
    s_sub_u32 s101, s101, 1
    s_cselect_b32 s98, 0, 4
    s_waitcnt lgkmcnt(0)
    v_readfirstlane_b32 s80, v10
    s_nop 0
    s_cmp_lt_u32 s80, s98
    s_cbranch_scc1 L_sw_47
    s_load_dword s8, s[20:21], 0 glc
    s_waitcnt vmcnt(6)
    v_mfma_f32_32x32x16_bf16 v[80:95], v[184:187], v[36:39], v[80:95]
    v_add_f32 v217, v217, v235
    v_add_f32 v224, v224, v236
    v_add_f32 v218, v218, v237
    v_lshlrev_b32 v241, 16, v227
    v_lshlrev_b32 v219, 16, v222
    v_mfma_f32_32x32x16_bf16 v[112:127], v[188:191], v[36:39], v[112:127]
    v_rcp_f32 v241, v241
    v_and_b32 v225, s38, v222
    v_lshlrev_b32 v220, 16, v223
    v_and_b32 v221, s38, v223
    v_and_b32 v240, s38, v227
    s_waitcnt vmcnt(5)
    v_mfma_f32_32x32x16_bf16 v[64:79], v[192:195], v[40:43], v[64:79]
    v_sub_f32 v234, v219, v240
    v_sub_f32 v235, v225, v240
    v_sub_f32 v236, v220, v240
    v_sub_f32 v237, v221, v240
    v_cvt_pk_bf16_f32 v238, v234, v235
    v_mfma_f32_32x32x16_bf16 v[96:111], v[196:199], v[40:43], v[96:111]
    v_cvt_pk_bf16_f32 v239, v236, v237
    v_lshlrev_b32 v234, 16, v238
    v_and_b32 v235, s38, v238
    v_lshlrev_b32 v236, 16, v239
    v_and_b32 v237, s38, v239
    s_waitcnt vmcnt(4)
    v_mfma_f32_32x32x16_bf16 v[64:79], v[200:203], v[44:47], v[64:79]
    v_mul_f32 v234, v234, v241
    v_mul_f32 v235, v235, v241
    v_mul_f32 v236, v236, v241
    v_mul_f32 v237, v237, v241
    v_cvt_pk_bf16_f32 v238, v234, v235
    v_mfma_f32_32x32x16_bf16 v[96:111], v[204:207], v[44:47], v[96:111]
    v_cvt_pk_bf16_f32 v239, v236, v237
    v_lshlrev_b32 v234, 16, v238
    v_and_b32 v235, s38, v238
    v_lshlrev_b32 v236, 16, v239
    v_and_b32 v237, s38, v239
    s_waitcnt vmcnt(3)
    v_mfma_f32_32x32x16_bf16 v[64:79], v[208:211], v[16:19], v[64:79]
    v_mul_f32 v234, v234, v230
    v_mul_f32 v235, v235, v231
    v_mul_f32 v236, v236, v232
    v_mul_f32 v237, v237, v233
    v_cvt_pk_bf16_f32 v238, v234, v235
    v_mfma_f32_32x32x16_bf16 v[96:111], v[212:215], v[16:19], v[96:111]
    v_cvt_pk_bf16_f32 v239, v236, v237
    v_lshlrev_b32 v234, 16, v238
    v_and_b32 v235, s38, v238
    v_lshlrev_b32 v236, 16, v239
    v_and_b32 v237, s38, v239
    s_waitcnt vmcnt(2)
    v_mfma_f32_32x32x16_bf16 v[80:95], v[192:195], v[20:23], v[80:95]
    v_add_f32 v219, v219, v234
    v_add_f32 v225, v225, v235
    v_add_f32 v220, v220, v236
    v_add_f32 v221, v221, v237
    v_mfma_f32_32x32x16_bf16 v[112:127], v[196:199], v[20:23], v[112:127]
    ds_write_b128 v4, v[64:67] offset:0
    ds_write_b128 v5, v[68:71] offset:0
    ds_write_b128 v6, v[72:75] offset:0
    ds_write_b128 v7, v[76:79] offset:0
    s_waitcnt vmcnt(1)
    v_mfma_f32_32x32x16_bf16 v[80:95], v[200:203], v[24:27], v[80:95]
    ds_write_b128 v4, v[96:99] offset:4096
    ds_write_b128 v5, v[100:103] offset:4096
    ds_write_b128 v6, v[104:107] offset:4096
    ds_write_b128 v7, v[108:111] offset:4096
    v_mfma_f32_32x32x16_bf16 v[112:127], v[204:207], v[24:27], v[112:127]
    s_waitcnt vmcnt(0)
    v_mfma_f32_32x32x16_bf16 v[80:95], v[208:211], v[28:31], v[80:95]
    v_mfma_f32_32x32x16_bf16 v[112:127], v[212:215], v[28:31], v[112:127]
    s_nop 10
    ds_write_b128 v4, v[80:83] offset:8192
    ds_write_b128 v5, v[84:87] offset:8192
    ds_write_b128 v6, v[88:91] offset:8192
    ds_write_b128 v7, v[92:95] offset:8192
    ds_write_b128 v4, v[112:115] offset:12288
    ds_write_b128 v5, v[116:119] offset:12288
    ds_write_b128 v6, v[120:123] offset:12288
    ds_write_b128 v7, v[124:127] offset:12288
    s_mov_b64 exec, 1
    ds_add_u32 v8, v9 offset:8
    s_mov_b64 exec, -1
    s_mov_b32 s83, 131072
L_fp_48:
    s_waitcnt lgkmcnt(0)
    s_cmp_lg_u32 s8, s78
    s_cbranch_scc1 L_fr_50
L_fd_49:
    buffer_load_dwordx4 v[16:19], v2, s[68:71], s23 offen offset:0 sc1
    buffer_load_dwordx4 v[20:23], v2, s[68:71], s23 offen offset:1024 sc1
    s_mov_b32 s101, 0x1000000
L_sw_51:
    s_sleep 1
    ds_read_b32 v10, v8 offset:8
    s_sub_u32 s101, s101, 1
    s_cselect_b32 s98, 0, 4
    s_waitcnt lgkmcnt(0)
    v_readfirstlane_b32 s80, v10
    s_nop 0
    s_cmp_lt_u32 s80, s98
    s_cbranch_scc1 L_sw_51
    ds_read_b128 v[128:131], v12 offset:0
    ds_read_b128 v[132:135], v12 offset:20480
    ds_read_b128 v[136:139], v13 offset:0
    ds_read_b128 v[140:143], v13 offset:20480
    ds_read_b128 v[144:147], v12 offset:2048
    ds_read_b128 v[148:151], v12 offset:22528
    ds_read_b128 v[152:155], v13 offset:2048
    ds_read_b128 v[156:159], v13 offset:22528
    ds_read_b128 v[160:163], v12 offset:8192
    ds_read_b128 v[164:167], v12 offset:28672
    ds_read_b128 v[168:171], v13 offset:8192
    ds_read_b128 v[172:175], v13 offset:28672
    ds_read_b128 v[176:179], v12 offset:10240
    ds_read_b128 v[180:183], v12 offset:30720
    ds_read_b128 v[184:187], v13 offset:10240
    ds_read_b128 v[188:191], v13 offset:30720
    s_waitcnt lgkmcnt(12)
    v_add_f32 v128, v128, v132
    v_add_f32 v129, v129, v133
    v_add_f32 v130, v130, v134
    v_add_f32 v131, v131, v135
    v_add_f32 v136, v136, v140
    v_add_f32 v137, v137, v141
    v_add_f32 v138, v138, v142
    v_add_f32 v139, v139, v143
    v_add_f32 v48, v248, v128
    v_add_f32 v49, v249, v129
    v_add_f32 v50, v250, v130
    v_add_f32 v51, v251, v131
    v_add_f32 v48, v48, v136
    v_add_f32 v49, v49, v137
    v_add_f32 v50, v50, v138
    v_add_f32 v51, v51, v139
    s_waitcnt lgkmcnt(8)
    v_add_f32 v144, v144, v148
    v_add_f32 v145, v145, v149
    v_add_f32 v146, v146, v150
    v_add_f32 v147, v147, v151
    v_add_f32 v152, v152, v156
    v_add_f32 v153, v153, v157
    v_add_f32 v154, v154, v158
    v_add_f32 v155, v155, v159
    v_add_f32 v52, v252, v144
    v_add_f32 v53, v253, v145
    v_add_f32 v54, v247, v146
    v_add_f32 v55, v11, v147
    v_add_f32 v52, v52, v152
    v_add_f32 v53, v53, v153
    v_add_f32 v54, v54, v154
    v_add_f32 v55, v55, v155
    s_waitcnt lgkmcnt(4)
    v_add_f32 v160, v160, v164
    v_add_f32 v161, v161, v165
    v_add_f32 v162, v162, v166
    v_add_f32 v163, v163, v167
    v_add_f32 v168, v168, v172
    v_add_f32 v169, v169, v173
    v_add_f32 v170, v170, v174
    v_add_f32 v171, v171, v175
    v_add_f32 v56, v216, v160
    v_add_f32 v57, v217, v161
    v_add_f32 v58, v224, v162
    v_add_f32 v59, v218, v163
    v_add_f32 v56, v56, v168
    v_add_f32 v57, v57, v169
    v_add_f32 v58, v58, v170
    v_add_f32 v59, v59, v171
    s_waitcnt lgkmcnt(0)
    v_add_f32 v176, v176, v180
    v_add_f32 v177, v177, v181
    v_add_f32 v178, v178, v182
    v_add_f32 v179, v179, v183
    v_add_f32 v184, v184, v188
    v_add_f32 v185, v185, v189
    v_add_f32 v186, v186, v190
    v_add_f32 v187, v187, v191
    v_add_f32 v60, v219, v176
    v_add_f32 v61, v225, v177
    v_add_f32 v62, v220, v178
    v_add_f32 v63, v221, v179
    v_add_f32 v60, v60, v184
    v_add_f32 v61, v61, v185
    v_add_f32 v62, v62, v186
    v_add_f32 v63, v63, v187
    s_waitcnt vmcnt(0)
    v_lshlrev_b32 v32, 16, v16
    v_and_b32 v33, s38, v16
    v_add_f32 v48, v48, v32
    v_add_f32 v49, v49, v33
    v_lshlrev_b32 v32, 16, v17
    v_and_b32 v33, s38, v17
    v_add_f32 v50, v50, v32
    v_add_f32 v51, v51, v33
    v_lshlrev_b32 v32, 16, v18
    v_and_b32 v33, s38, v18
    v_add_f32 v52, v52, v32
    v_add_f32 v53, v53, v33
    v_lshlrev_b32 v32, 16, v19
    v_and_b32 v33, s38, v19
    v_add_f32 v54, v54, v32
    v_add_f32 v55, v55, v33
    v_lshlrev_b32 v32, 16, v20
    v_and_b32 v33, s38, v20
    v_add_f32 v56, v56, v32
    v_add_f32 v57, v57, v33
    v_lshlrev_b32 v32, 16, v21
    v_and_b32 v33, s38, v21
    v_add_f32 v58, v58, v32
    v_add_f32 v59, v59, v33
    v_lshlrev_b32 v32, 16, v22
    v_and_b32 v33, s38, v22
    v_add_f32 v60, v60, v32
    v_add_f32 v61, v61, v33
    v_lshlrev_b32 v32, 16, v23
    v_and_b32 v33, s38, v23
    v_add_f32 v62, v62, v32
    v_add_f32 v63, v63, v33
    s_mov_b32 s101, 0x1000000
L_sw_52:
    s_sleep 1
    ds_read_b32 v20, v8 offset:12
    s_sub_u32 s101, s101, 1
    s_cselect_b32 s98, 0, 4
    s_waitcnt lgkmcnt(0)
    v_readfirstlane_b32 s80, v20
    s_nop 0
    s_cmp_lt_u32 s80, s98
    s_cbranch_scc1 L_sw_52
    ds_read_b128 v[128:131], v14 offset:0
    ds_read_b128 v[132:135], v14 offset:16384
    ds_read_b128 v[136:139], v14 offset:32768
    ds_read_b128 v[140:143], v14 offset:49152
    ds_read_b128 v[144:147], v14 offset:2048
    ds_read_b128 v[148:151], v14 offset:18432
    ds_read_b128 v[152:155], v14 offset:34816
    ds_read_b128 v[156:159], v14 offset:51200
    s_waitcnt lgkmcnt(4)
    v_add_f32 v128, v128, v132
    v_add_f32 v129, v129, v133
    v_add_f32 v130, v130, v134
    v_add_f32 v131, v131, v135
    v_add_f32 v136, v136, v140
    v_add_f32 v137, v137, v141
    v_add_f32 v138, v138, v142
    v_add_f32 v139, v139, v143
    v_add_f32 v48, v48, v128
    v_add_f32 v49, v49, v129
    v_add_f32 v50, v50, v130
    v_add_f32 v51, v51, v131
    v_add_f32 v48, v48, v136
    v_add_f32 v49, v49, v137
    v_add_f32 v50, v50, v138
    v_add_f32 v51, v51, v139
    buffer_store_dwordx4 v[48:51], v15, s[64:67], s4 offen sc1
    s_waitcnt lgkmcnt(0)
    v_add_f32 v144, v144, v148
    v_add_f32 v145, v145, v149
    v_add_f32 v146, v146, v150
    v_add_f32 v147, v147, v151
    v_add_f32 v152, v152, v156
    v_add_f32 v153, v153, v157
    v_add_f32 v154, v154, v158
    v_add_f32 v155, v155, v159
    v_add_f32 v52, v52, v144
    v_add_f32 v53, v53, v145
    v_add_f32 v54, v54, v146
    v_add_f32 v55, v55, v147
    v_add_f32 v52, v52, v152
    v_add_f32 v53, v53, v153
    v_add_f32 v54, v54, v154
    v_add_f32 v55, v55, v155
    s_add_u32 s4, s4, 16384
    buffer_store_dwordx4 v[52:55], v15, s[64:67], s4 offen sc1
    s_mov_b32 s101, 0x1000000
L_sw_53:
    s_sleep 1
    ds_read_b32 v20, v8 offset:16
    s_sub_u32 s101, s101, 1
    s_cselect_b32 s98, 0, 4
    s_waitcnt lgkmcnt(0)
    v_readfirstlane_b32 s80, v20
    s_nop 0
    s_cmp_lt_u32 s80, s98
    s_cbranch_scc1 L_sw_53
    ds_read_b128 v[160:163], v14 offset:8192
    ds_read_b128 v[164:167], v14 offset:24576
    ds_read_b128 v[168:171], v14 offset:40960
    ds_read_b128 v[172:175], v14 offset:57344
    ds_read_b128 v[176:179], v14 offset:10240
    ds_read_b128 v[180:183], v14 offset:26624
    ds_read_b128 v[184:187], v14 offset:43008
    ds_read_b128 v[188:191], v14 offset:59392
    s_waitcnt lgkmcnt(4)
    v_pk_add_f32 v[160:161], v[160:161], v[164:165]
    v_pk_add_f32 v[162:163], v[162:163], v[166:167]
    v_pk_add_f32 v[168:169], v[168:169], v[172:173]
    v_pk_add_f32 v[170:171], v[170:171], v[174:175]
    v_pk_add_f32 v[56:57], v[56:57], v[160:161]
    v_pk_add_f32 v[58:59], v[58:59], v[162:163]
    v_pk_add_f32 v[56:57], v[56:57], v[168:169]
    v_pk_add_f32 v[58:59], v[58:59], v[170:171]
    s_add_u32 s4, s4, 49152
    buffer_store_dwordx4 v[56:59], v15, s[64:67], s4 offen sc1
    s_waitcnt lgkmcnt(0)
    v_pk_add_f32 v[176:177], v[176:177], v[180:181]
    v_pk_add_f32 v[178:179], v[178:179], v[182:183]
    v_pk_add_f32 v[184:185], v[184:185], v[188:189]
    v_pk_add_f32 v[186:187], v[186:187], v[190:191]
    v_pk_add_f32 v[60:61], v[60:61], v[176:177]
    v_pk_add_f32 v[62:63], v[62:63], v[178:179]
    v_pk_add_f32 v[60:61], v[60:61], v[184:185]
    v_pk_add_f32 v[62:63], v[62:63], v[186:187]
    s_add_u32 s4, s4, 16384
    buffer_store_dwordx4 v[60:63], v15, s[64:67], s4 offen sc1
    s_cmp_lg_u32 s2, 0xff
    s_cbranch_scc1 L_noep
    s_cmp_lg_u32 s72, 0
    s_cbranch_scc1 L_noep
    v_mov_b32 v20, s78
    v_mov_b32 v21, 0
    s_mov_b64 exec, 1
    buffer_store_dword v20, v21, s[68:71], 0 offen sc1
    s_mov_b64 exec, -1
L_noep:
    s_endpgm
L_gr_41:
    s_sleep 8
    s_mov_b32 exec_hi, 0
    buffer_load_dwordx2 v[28:29], v30, s[68:71], s4 offen sc1
    s_mov_b64 exec, -1
    buffer_load_dwordx4 v[208:211], v31, s[68:71], s17 offen sc1
    buffer_load_dwordx4 v[212:215], v31, s[68:71], s17 offen offset:1024 sc1
    s_waitcnt vmcnt(0)
    s_sub_u32 s83, s83, 1
    s_cmp_lg_u32 s83, 0
    s_cbranch_scc1 L_gc_40
    s_branch L_gx_42
L_fr_45:
    s_cmp_eq_u32 s83, 131072
    s_cbranch_scc1 L_ff_54
    s_sleep 2
L_ff_54:
    s_load_dwordx4 s[8:11], s[20:21], 0 glc
    s_load_dwordx4 s[12:15], s[20:21], 128 glc
    s_load_dwordx4 s[16:19], s[20:21], 256 glc
    s_sub_u32 s83, s83, 1
    s_cmp_lg_u32 s83, 0
    s_cbranch_scc1 L_fp_43
    s_waitcnt lgkmcnt(0)
    s_branch L_fd_44
L_fr_50:
    s_cmp_eq_u32 s83, 131072
    s_cbranch_scc1 L_ff_55
    s_sleep 2
L_ff_55:
    s_load_dword s8, s[20:21], 0 glc
    s_sub_u32 s83, s83, 1
    s_cmp_lg_u32 s83, 0
    s_cbranch_scc1 L_fp_48
    s_waitcnt lgkmcnt(0)
    s_branch L_fd_49
L_end:
    s_endpgm
.section .rodata,"a"
.p2align 6
.amdhsa_kernel parallel_sum__ssm_conv_s5__dense_activation_silu__prompt_kernel
  .amdhsa_next_free_vgpr 256
  .amdhsa_next_free_sgpr 102
  .amdhsa_accum_offset 256
  .amdhsa_group_segment_fixed_size 0
  .amdhsa_kernarg_size 120
  .amdhsa_user_sgpr_count 2
  .amdhsa_user_sgpr_kernarg_segment_ptr 1
  .amdhsa_system_sgpr_workgroup_id_x 1
.end_amdhsa_kernel
```
